```python
import torch

def _softmax(x, axis=-1):
    return torch.softmax(x, dim=axis)
def _gelu(x):
    return torch.nn.functional.gelu(x, approximate="tanh")
def _silu(x):
    return torch.nn.functional.silu(x)
def _sigmoid(x):
    return torch.sigmoid(x)
def _layernorm(x, axis=-1, eps=1e-5):
    m = x.mean(dim=axis, keepdim=True)
    v = x.var(dim=axis, keepdim=True, unbiased=False)
    return (x - m) / torch.sqrt(v + eps)
def _scatter_add(tgt, idx, src, axis=0):
    return tgt.clone().index_add_(axis, idx, src)
def _segment_sum(src, seg, n):
    out = torch.zeros((n,) + src.shape[1:], dtype=src.dtype)
    return out.index_add_(0, seg, src)
def _pad(x, pw):
    flat = tuple(v for pair in reversed(pw) for v in pair)
    return torch.nn.functional.pad(x, flat)

kernel_name = 'standalone__gqa_block_cached__near_ridge'

def setup_inputs():

    _w = (lambda a: (lambda t: t.to(torch.bfloat16) if t.is_floating_point() else t)(torch.as_tensor(a)))
    B, Sq, D = 16, 64, 448
    Hq, Hkv, Sk, Dh = 16, 8, 512, 256
    assert Hq % Hkv == 0, (Hq, Hkv)
    return {
        "x": _w((lambda *s: torch.randn(*s, dtype=torch.bfloat16) * 0.8)(B, Sq, D)),
        "k_cache": _w((lambda *s: torch.randn(*s, dtype=torch.bfloat16) * 0.8)(B, Hkv, Sk, Dh)),
        "v_cache": _w((lambda *s: torch.randn(*s, dtype=torch.bfloat16) * 0.05)(B, Hkv, Sk, Dh)),
        "wq": _w((lambda *s: torch.randn(*s, dtype=torch.bfloat16) * 0.8)(D, Hq * Dh) * (D ** -0.5)),
        "wo": _w((lambda *s: torch.randn(*s, dtype=torch.bfloat16) * 0.05)(Hq * Dh, D) * ((Hq * Dh) ** -0.5)),
    }

def reference(x, k_cache, v_cache, wq, wo):
    B, Sq, D = x.shape
    Hq, Dh = 16, 256
    Hkv = k_cache.shape[1]
    rep = Hq // Hkv
    q = (lambda x, *d: x.permute(*d))((x @ wq).reshape(B, Sq, Hq, Dh), 0, 2, 1, 3)
    k = (lambda x, n, axis: torch.repeat_interleave(x, n, dim=axis))(k_cache, rep, axis=1)
    v = (lambda x, n, axis: torch.repeat_interleave(x, n, dim=axis))(v_cache, rep, axis=1)
    scores = torch.einsum("bhqd,bhkd->bhqk", q, k) * (Dh ** -0.5)
    p = _softmax(scores, axis=-1)
    o = torch.einsum("bhqk,bhkd->bhqd", p, v)
    return (lambda x, *d: x.permute(*d))(o, 0, 2, 1, 3).reshape(B, Sq, Hq * Dh) @ wo
```

```asm
; @launch kernel=gqa_main_kernel grid=(256,1,1) block=(512,1,1) lds=163840
; @launch kernel=gqa_reduce_kernel grid=(224,1,1) block=(256,1,1) lds=0
.amdgcn_target "amdgcn-amd-amdhsa--gfx950"
.text
.globl gqa_main_kernel
.p2align 8
.type gqa_main_kernel,@function
gqa_main_kernel:
    s_cmp_ge_u32 s2, 256
    s_cbranch_scc1 L1_end
    s_load_dwordx16 s[16:31], s[0:1], 0
    v_lshrrev_b32 v1, 6, v0
    v_and_b32 v0, 63, v0
    v_readfirstlane_b32 s3, v1
    s_and_b32 s4, s2, 7
    s_lshr_b32 s5, s2, 4
    s_bfe_u32 s7, s2, 0x10003
    s_lshl_b32 s6, s4, 1
    s_add_u32 s6, s6, s7
    s_cmp_ge_u32 s3, 4
    s_cbranch_scc1 L1_load
L1_comp:
    s_and_b32 s8, s3, 1
    s_lshr_b32 s9, s3, 1
    s_setprio 2
    s_lshl_b32 s11, s6, 9
    s_mul_i32 s10, s5, 28
    s_mul_i32 s13, s3, 7
    s_add_u32 s10, s10, s13
    s_lshl_b32 s10, s10, 13
    v_bfe_u32 v15, v0, 2, 3
    v_lshlrev_b32 v15, 13, v15
    v_and_b32 v13, 3, v0
    v_lshl_add_u32 v15, v13, 7, v15
    s_waitcnt lgkmcnt(0)
    s_add_u32 s88, s22, s11
    s_addc_u32 s89, s23, 0
    s_and_b32 s89, s89, 0xffff
    s_sub_u32 s90, 3670016, s11
    s_mov_b32 s91, 0x20000
    buffer_load_dword v59, v15, s[88:91], s10 offen
    s_mul_i32 s11, s6, 229376
    s_add_u32 s92, s24, s11
    s_addc_u32 s93, s25, 0
    s_and_b32 s93, s93, 0xffff
    s_mov_b32 s94, 229376
    s_mov_b32 s95, 0x20000
    s_lshl_b32 s10, s5, 4
    s_add_u32 s10, s10, s6
    s_mul_i32 s10, s10, 57344
    s_add_u32 s32, s30, s10
    s_addc_u32 s33, s31, 0
    s_and_b32 s33, s33, 0xffff
    s_mov_b32 s34, 57344
    s_mov_b32 s35, 0x20000
    s_mov_b32 s12, 0x3db8aa3b
    v_lshrrev_b32 v16, 5, v0
    v_and_b32 v17, 31, v0
    s_lshl_b32 s10, s9, 12
    v_lshlrev_b32 v18, 7, v17
    v_add_u32 v18, s10, v18
    v_bfe_u32 v19, v0, 1, 3
    v_xor_b32 v19, v19, v16
    v_xor_b32 v20, 0, v19
    v_lshl_add_u32 v40, v20, 4, v18
    v_xor_b32 v20, 2, v19
    v_lshl_add_u32 v41, v20, 4, v18
    v_xor_b32 v20, 4, v19
    v_lshl_add_u32 v42, v20, 4, v18
    v_xor_b32 v20, 6, v19
    v_lshl_add_u32 v43, v20, 4, v18
    v_bfe_u32 v17, v0, 2, 2
    v_lshl_add_u32 v18, v16, 3, v17
    v_lshlrev_b32 v18, 9, v18
    s_lshl_b32 s10, s8, 8
    v_add_u32 v18, s10, v18
    v_bfe_u32 v19, v0, 4, 1
    v_lshl_add_u32 v18, v19, 5, v18
    v_and_b32 v19, 1, v0
    v_lshl_add_u32 v18, v19, 4, v18
    v_bfe_u32 v19, v0, 1, 1
    v_lshl_add_u32 v18, v19, 3, v18
    v_xor_b32 v19, 0, v17
    v_lshl_add_u32 v9, v19, 6, v18
    v_xor_b32 v19, 1, v17
    v_lshl_add_u32 v10, v19, 6, v18
    v_xor_b32 v19, 2, v17
    v_lshl_add_u32 v11, v19, 6, v18
    v_xor_b32 v19, 3, v17
    v_lshl_add_u32 v12, v19, 6, v18
    s_barrier
    ds_read_b64_tr_b16 v[16:17], v9 offset:16384
    ds_read_b64_tr_b16 v[18:19], v9 offset:18432
    ds_read_b64_tr_b16 v[20:21], v10 offset:16384
    ds_read_b64_tr_b16 v[22:23], v10 offset:18432
    ds_read_b64_tr_b16 v[24:25], v11 offset:16384
    ds_read_b64_tr_b16 v[26:27], v11 offset:18432
    ds_read_b64_tr_b16 v[28:29], v12 offset:16384
    ds_read_b64_tr_b16 v[30:31], v12 offset:18432
    ds_read_b64_tr_b16 v[32:33], v9 offset:24576
    ds_read_b64_tr_b16 v[34:35], v9 offset:26624
    ds_read_b128 v[64:67], v40 offset:0
    ds_read_b128 v[68:71], v41 offset:0
    s_waitcnt lgkmcnt(1)
    v_mfma_f32_32x32x16_bf16 v[192:207], v[16:19], v[64:67], 0
    ds_read_b64_tr_b16 v[36:37], v10 offset:24576
    ds_read_b64_tr_b16 v[38:39], v10 offset:26624
    ds_read_b128 v[72:75], v42 offset:0
    ds_read_b128 v[76:79], v43 offset:0
    ds_read_b128 v[80:83], v40 offset:8192
    v_mfma_f32_32x32x16_bf16 v[208:223], v[20:23], v[64:67], 0
    ds_read_b64_tr_b16 v[16:17], v11 offset:24576
    ds_read_b64_tr_b16 v[18:19], v11 offset:26624
    ds_read_b128 v[84:87], v41 offset:8192
    ds_read_b128 v[88:91], v42 offset:8192
    ds_read_b128 v[92:95], v43 offset:8192
    v_mfma_f32_32x32x16_bf16 v[224:239], v[24:27], v[64:67], 0
    ds_read_b64_tr_b16 v[20:21], v12 offset:24576
    ds_read_b64_tr_b16 v[22:23], v12 offset:26624
    v_mfma_f32_32x32x16_bf16 v[240:255], v[28:31], v[64:67], 0
    ds_read_b64_tr_b16 v[24:25], v9 offset:32768
    ds_read_b64_tr_b16 v[26:27], v9 offset:34816
    s_waitcnt lgkmcnt(14)
    v_mfma_f32_32x32x16_bf16 v[192:207], v[32:35], v[68:71], v[192:207]
    ds_read_b64_tr_b16 v[28:29], v10 offset:32768
    ds_read_b64_tr_b16 v[30:31], v10 offset:34816
    s_waitcnt lgkmcnt(14)
    v_mfma_f32_32x32x16_bf16 v[208:223], v[36:39], v[68:71], v[208:223]
    ds_read_b64_tr_b16 v[32:33], v11 offset:32768
    ds_read_b64_tr_b16 v[34:35], v11 offset:34816
    s_waitcnt lgkmcnt(11)
    v_mfma_f32_32x32x16_bf16 v[224:239], v[16:19], v[68:71], v[224:239]
    ds_read_b64_tr_b16 v[36:37], v12 offset:32768
    ds_read_b64_tr_b16 v[38:39], v12 offset:34816
    s_waitcnt lgkmcnt(8)
    v_mfma_f32_32x32x16_bf16 v[240:255], v[20:23], v[68:71], v[240:255]
    ds_read_b64_tr_b16 v[16:17], v9 offset:40960
    ds_read_b64_tr_b16 v[18:19], v9 offset:43008
    s_waitcnt lgkmcnt(8)
    s_barrier
    v_mfma_f32_32x32x16_bf16 v[192:207], v[24:27], v[72:75], v[192:207]
    ds_read_b64_tr_b16 v[20:21], v10 offset:40960
    ds_read_b64_tr_b16 v[22:23], v10 offset:43008
    s_waitcnt lgkmcnt(8)
    s_lshl_b32 s11, s8, 13
    v_and_b32 v15, 31, v0
    v_lshlrev_b32 v15, 8, v15
    v_mfma_f32_32x32x16_bf16 v[208:223], v[28:31], v[72:75], v[208:223]
    ds_read_b64_tr_b16 v[24:25], v11 offset:40960
    ds_read_b64_tr_b16 v[26:27], v11 offset:43008
    s_waitcnt lgkmcnt(8)
    v_add_u32 v15, s11, v15
    v_and_b32 v1, 15, v0
    v_lshrrev_b32 v2, 5, v0
    v_mfma_f32_32x32x16_bf16 v[224:239], v[32:35], v[72:75], v[224:239]
    ds_read_b64_tr_b16 v[28:29], v12 offset:40960
    ds_read_b64_tr_b16 v[30:31], v12 offset:43008
    s_waitcnt lgkmcnt(8)
    v_xor_b32 v1, v1, v2
    v_lshl_add_u32 v15, v1, 4, v15
    v_xor_b32 v1, 0, v15
    v_mfma_f32_32x32x16_bf16 v[240:255], v[36:39], v[72:75], v[240:255]
    ds_read_b64_tr_b16 v[32:33], v9 offset:49152
    ds_read_b64_tr_b16 v[34:35], v9 offset:51200
    s_waitcnt lgkmcnt(8)
    v_xor_b32 v2, 32, v15
    v_xor_b32 v3, 64, v15
    v_xor_b32 v4, 96, v15
    v_mfma_f32_32x32x16_bf16 v[192:207], v[16:19], v[76:79], v[192:207]
    ds_read_b64_tr_b16 v[36:37], v10 offset:49152
    ds_read_b64_tr_b16 v[38:39], v10 offset:51200
    s_waitcnt lgkmcnt(8)
    v_xor_b32 v5, 128, v15
    v_xor_b32 v6, 160, v15
    v_xor_b32 v7, 192, v15
    v_mfma_f32_32x32x16_bf16 v[208:223], v[20:23], v[76:79], v[208:223]
    ds_read_b64_tr_b16 v[16:17], v11 offset:49152
    ds_read_b64_tr_b16 v[18:19], v11 offset:51200
    s_waitcnt lgkmcnt(8)
    v_xor_b32 v8, 224, v15
    v_mfma_f32_32x32x16_bf16 v[224:239], v[24:27], v[76:79], v[224:239]
    ds_read_b64_tr_b16 v[20:21], v12 offset:49152
    ds_read_b64_tr_b16 v[22:23], v12 offset:51200
    s_waitcnt lgkmcnt(8)
    s_mul_i32 s14, s9, 16384
    s_add_u32 s14, s14, 16384
    s_lshl_b32 s11, s8, 13
    s_add_u32 s11, s11, s14
    v_lshl_add_u32 v13, v0, 4, s11
    v_mfma_f32_32x32x16_bf16 v[240:255], v[28:31], v[76:79], v[240:255]
    ds_read_b64_tr_b16 v[24:25], v9 offset:57344
    ds_read_b64_tr_b16 v[26:27], v9 offset:59392
    s_waitcnt lgkmcnt(8)
    s_barrier
    v_mfma_f32_32x32x16_bf16 v[192:207], v[32:35], v[80:83], v[192:207]
    ds_read_b64_tr_b16 v[28:29], v10 offset:57344
    ds_read_b64_tr_b16 v[30:31], v10 offset:59392
    s_waitcnt lgkmcnt(8)
    v_mfma_f32_32x32x16_bf16 v[208:223], v[36:39], v[80:83], v[208:223]
    ds_read_b64_tr_b16 v[32:33], v11 offset:57344
    ds_read_b64_tr_b16 v[34:35], v11 offset:59392
    s_waitcnt lgkmcnt(8)
    v_mfma_f32_32x32x16_bf16 v[224:239], v[16:19], v[80:83], v[224:239]
    ds_read_b64_tr_b16 v[36:37], v12 offset:57344
    ds_read_b64_tr_b16 v[38:39], v12 offset:59392
    s_waitcnt lgkmcnt(8)
    v_mfma_f32_32x32x16_bf16 v[240:255], v[20:23], v[80:83], v[240:255]
    v_add_u32 v9, 0x10000, v9
    ds_read_b64_tr_b16 v[16:17], v9 offset:0
    ds_read_b64_tr_b16 v[18:19], v9 offset:2048
    s_waitcnt lgkmcnt(8)
    v_mfma_f32_32x32x16_bf16 v[192:207], v[24:27], v[84:87], v[192:207]
    v_add_u32 v10, 0x10000, v10
    ds_read_b64_tr_b16 v[20:21], v10 offset:0
    ds_read_b64_tr_b16 v[22:23], v10 offset:2048
    s_waitcnt lgkmcnt(8)
    v_mfma_f32_32x32x16_bf16 v[208:223], v[28:31], v[84:87], v[208:223]
    v_add_u32 v11, 0x10000, v11
    ds_read_b64_tr_b16 v[24:25], v11 offset:0
    ds_read_b64_tr_b16 v[26:27], v11 offset:2048
    s_waitcnt lgkmcnt(8)
    v_mfma_f32_32x32x16_bf16 v[224:239], v[32:35], v[84:87], v[224:239]
    v_add_u32 v12, 0x10000, v12
    ds_read_b64_tr_b16 v[28:29], v12 offset:0
    ds_read_b64_tr_b16 v[30:31], v12 offset:2048
    s_waitcnt lgkmcnt(8)
    v_mfma_f32_32x32x16_bf16 v[240:255], v[36:39], v[84:87], v[240:255]
    ds_read_b64_tr_b16 v[32:33], v9 offset:8192
    ds_read_b64_tr_b16 v[34:35], v9 offset:10240
    s_waitcnt lgkmcnt(8)
    s_barrier
    v_mfma_f32_32x32x16_bf16 v[192:207], v[16:19], v[88:91], v[192:207]
    ds_read_b64_tr_b16 v[36:37], v10 offset:8192
    ds_read_b64_tr_b16 v[38:39], v10 offset:10240
    s_waitcnt lgkmcnt(8)
    v_add_u32 v40, 0x10000, v40
    ds_read_b128 v[96:99], v40 offset:16384
    v_add_u32 v41, 0x10000, v41
    ds_read_b128 v[100:103], v41 offset:16384
    v_add_u32 v42, 0x10000, v42
    ds_read_b128 v[104:107], v42 offset:16384
    v_mfma_f32_32x32x16_bf16 v[208:223], v[20:23], v[88:91], v[208:223]
    ds_read_b64_tr_b16 v[16:17], v11 offset:8192
    ds_read_b64_tr_b16 v[18:19], v11 offset:10240
    s_waitcnt lgkmcnt(11)
    v_add_u32 v43, 0x10000, v43
    ds_read_b128 v[108:111], v43 offset:16384
    ds_read_b128 v[112:115], v40 offset:24576
    ds_read_b128 v[116:119], v41 offset:24576
    v_mfma_f32_32x32x16_bf16 v[224:239], v[24:27], v[88:91], v[224:239]
    ds_read_b64_tr_b16 v[20:21], v12 offset:8192
    ds_read_b64_tr_b16 v[22:23], v12 offset:10240
    s_waitcnt lgkmcnt(14)
    ds_read_b128 v[120:123], v42 offset:24576
    ds_read_b128 v[124:127], v43 offset:24576
    v_mfma_f32_32x32x16_bf16 v[240:255], v[28:31], v[88:91], v[240:255]
    ds_read_b64_tr_b16 v[24:25], v9 offset:32768
    ds_read_b64_tr_b16 v[26:27], v9 offset:34816
    s_waitcnt lgkmcnt(15)
    v_mfma_f32_32x32x16_bf16 v[192:207], v[32:35], v[92:95], v[192:207]
    ds_read_b64_tr_b16 v[28:29], v10 offset:32768
    ds_read_b64_tr_b16 v[30:31], v10 offset:34816
    s_waitcnt lgkmcnt(15)
    v_mfma_f32_32x32x16_bf16 v[208:223], v[36:39], v[92:95], v[208:223]
    ds_read_b64_tr_b16 v[32:33], v11 offset:32768
    ds_read_b64_tr_b16 v[34:35], v11 offset:34816
    s_waitcnt lgkmcnt(13)
    v_mfma_f32_32x32x16_bf16 v[224:239], v[16:19], v[92:95], v[224:239]
    ds_read_b64_tr_b16 v[36:37], v12 offset:32768
    ds_read_b64_tr_b16 v[38:39], v12 offset:34816
    s_waitcnt lgkmcnt(10)
    v_mfma_f32_32x32x16_bf16 v[240:255], v[20:23], v[92:95], v[240:255]
    ds_read_b64_tr_b16 v[16:17], v9 offset:40960
    ds_read_b64_tr_b16 v[18:19], v9 offset:43008
    s_waitcnt lgkmcnt(8)
    s_barrier
    v_mfma_f32_32x32x16_bf16 v[192:207], v[24:27], v[96:99], v[192:207]
    ds_read_b64_tr_b16 v[20:21], v10 offset:40960
    ds_read_b64_tr_b16 v[22:23], v10 offset:43008
    s_waitcnt lgkmcnt(8)
    v_mfma_f32_32x32x16_bf16 v[208:223], v[28:31], v[96:99], v[208:223]
    ds_read_b64_tr_b16 v[24:25], v11 offset:40960
    ds_read_b64_tr_b16 v[26:27], v11 offset:43008
    s_waitcnt lgkmcnt(8)
    v_mfma_f32_32x32x16_bf16 v[224:239], v[32:35], v[96:99], v[224:239]
    ds_read_b64_tr_b16 v[28:29], v12 offset:40960
    ds_read_b64_tr_b16 v[30:31], v12 offset:43008
    s_waitcnt lgkmcnt(8)
    v_mfma_f32_32x32x16_bf16 v[240:255], v[36:39], v[96:99], v[240:255]
    ds_read_b64_tr_b16 v[32:33], v9 offset:49152
    ds_read_b64_tr_b16 v[34:35], v9 offset:51200
    s_waitcnt lgkmcnt(8)
    v_mfma_f32_32x32x16_bf16 v[192:207], v[16:19], v[100:103], v[192:207]
    ds_read_b64_tr_b16 v[36:37], v10 offset:49152
    ds_read_b64_tr_b16 v[38:39], v10 offset:51200
    s_waitcnt lgkmcnt(8)
    v_mfma_f32_32x32x16_bf16 v[208:223], v[20:23], v[100:103], v[208:223]
    ds_read_b64_tr_b16 v[16:17], v11 offset:49152
    ds_read_b64_tr_b16 v[18:19], v11 offset:51200
    s_waitcnt lgkmcnt(8)
    v_mfma_f32_32x32x16_bf16 v[224:239], v[24:27], v[100:103], v[224:239]
    ds_read_b64_tr_b16 v[20:21], v12 offset:49152
    ds_read_b64_tr_b16 v[22:23], v12 offset:51200
    s_waitcnt lgkmcnt(8)
    v_mfma_f32_32x32x16_bf16 v[240:255], v[28:31], v[100:103], v[240:255]
    ds_read_b64_tr_b16 v[24:25], v9 offset:57344
    ds_read_b64_tr_b16 v[26:27], v9 offset:59392
    s_waitcnt lgkmcnt(8)
    s_barrier
    v_mfma_f32_32x32x16_bf16 v[192:207], v[32:35], v[104:107], v[192:207]
    ds_read_b64_tr_b16 v[28:29], v10 offset:57344
    ds_read_b64_tr_b16 v[30:31], v10 offset:59392
    s_waitcnt lgkmcnt(8)
    v_mfma_f32_32x32x16_bf16 v[208:223], v[36:39], v[104:107], v[208:223]
    ds_read_b64_tr_b16 v[32:33], v11 offset:57344
    ds_read_b64_tr_b16 v[34:35], v11 offset:59392
    s_waitcnt lgkmcnt(8)
    v_mfma_f32_32x32x16_bf16 v[224:239], v[16:19], v[104:107], v[224:239]
    ds_read_b64_tr_b16 v[36:37], v12 offset:57344
    ds_read_b64_tr_b16 v[38:39], v12 offset:59392
    s_waitcnt lgkmcnt(8)
    v_mfma_f32_32x32x16_bf16 v[240:255], v[20:23], v[104:107], v[240:255]
    v_add_u32 v9, 0x10000, v9
    ds_read_b64_tr_b16 v[16:17], v9 offset:0
    ds_read_b64_tr_b16 v[18:19], v9 offset:2048
    s_waitcnt lgkmcnt(8)
    v_mfma_f32_32x32x16_bf16 v[192:207], v[24:27], v[108:111], v[192:207]
    v_add_u32 v10, 0x10000, v10
    ds_read_b64_tr_b16 v[20:21], v10 offset:0
    ds_read_b64_tr_b16 v[22:23], v10 offset:2048
    s_waitcnt lgkmcnt(8)
    v_mfma_f32_32x32x16_bf16 v[208:223], v[28:31], v[108:111], v[208:223]
    v_add_u32 v11, 0x10000, v11
    ds_read_b64_tr_b16 v[24:25], v11 offset:0
    ds_read_b64_tr_b16 v[26:27], v11 offset:2048
    s_waitcnt lgkmcnt(8)
    v_mfma_f32_32x32x16_bf16 v[224:239], v[32:35], v[108:111], v[224:239]
    v_add_u32 v12, 0x10000, v12
    ds_read_b64_tr_b16 v[28:29], v12 offset:0
    ds_read_b64_tr_b16 v[30:31], v12 offset:2048
    s_waitcnt lgkmcnt(8)
    v_mfma_f32_32x32x16_bf16 v[240:255], v[36:39], v[108:111], v[240:255]
    ds_read_b64_tr_b16 v[32:33], v9 offset:8192
    ds_read_b64_tr_b16 v[34:35], v9 offset:10240
    s_waitcnt lgkmcnt(8)
    s_barrier
    v_mfma_f32_32x32x16_bf16 v[192:207], v[16:19], v[112:115], v[192:207]
    ds_read_b64_tr_b16 v[36:37], v10 offset:8192
    ds_read_b64_tr_b16 v[38:39], v10 offset:10240
    s_waitcnt lgkmcnt(8)
    v_mfma_f32_32x32x16_bf16 v[208:223], v[20:23], v[112:115], v[208:223]
    ds_read_b64_tr_b16 v[16:17], v11 offset:8192
    ds_read_b64_tr_b16 v[18:19], v11 offset:10240
    s_waitcnt lgkmcnt(8)
    v_mfma_f32_32x32x16_bf16 v[224:239], v[24:27], v[112:115], v[224:239]
    ds_read_b64_tr_b16 v[20:21], v12 offset:8192
    ds_read_b64_tr_b16 v[22:23], v12 offset:10240
    s_waitcnt lgkmcnt(8)
    v_mfma_f32_32x32x16_bf16 v[240:255], v[28:31], v[112:115], v[240:255]
    ds_read_b64_tr_b16 v[24:25], v9 offset:16384
    ds_read_b64_tr_b16 v[26:27], v9 offset:18432
    s_waitcnt lgkmcnt(8)
    v_mfma_f32_32x32x16_bf16 v[192:207], v[32:35], v[116:119], v[192:207]
    ds_read_b64_tr_b16 v[28:29], v10 offset:16384
    ds_read_b64_tr_b16 v[30:31], v10 offset:18432
    s_waitcnt lgkmcnt(8)
    v_mfma_f32_32x32x16_bf16 v[208:223], v[36:39], v[116:119], v[208:223]
    ds_read_b64_tr_b16 v[32:33], v11 offset:16384
    ds_read_b64_tr_b16 v[34:35], v11 offset:18432
    s_waitcnt lgkmcnt(8)
    v_mfma_f32_32x32x16_bf16 v[224:239], v[16:19], v[116:119], v[224:239]
    ds_read_b64_tr_b16 v[36:37], v12 offset:16384
    ds_read_b64_tr_b16 v[38:39], v12 offset:18432
    s_waitcnt lgkmcnt(8)
    v_mfma_f32_32x32x16_bf16 v[240:255], v[20:23], v[116:119], v[240:255]
    ds_read_b64_tr_b16 v[16:17], v9 offset:24576
    ds_read_b64_tr_b16 v[18:19], v9 offset:26624
    s_waitcnt lgkmcnt(8)
    s_barrier
    v_mfma_f32_32x32x16_bf16 v[192:207], v[24:27], v[120:123], v[192:207]
    ds_read_b64_tr_b16 v[20:21], v10 offset:24576
    ds_read_b64_tr_b16 v[22:23], v10 offset:26624
    s_waitcnt lgkmcnt(8)
    v_subrev_u32 v40, 0x10000, v40
    ds_read_b128 v[128:131], v40 offset:0
    v_subrev_u32 v41, 0x10000, v41
    ds_read_b128 v[132:135], v41 offset:0
    v_subrev_u32 v42, 0x10000, v42
    ds_read_b128 v[136:139], v42 offset:0
    v_mfma_f32_32x32x16_bf16 v[208:223], v[28:31], v[120:123], v[208:223]
    ds_read_b64_tr_b16 v[24:25], v11 offset:24576
    ds_read_b64_tr_b16 v[26:27], v11 offset:26624
    s_waitcnt lgkmcnt(11)
    v_subrev_u32 v43, 0x10000, v43
    ds_read_b128 v[140:143], v43 offset:0
    ds_read_b128 v[144:147], v40 offset:8192
    ds_read_b128 v[148:151], v41 offset:8192
    v_mfma_f32_32x32x16_bf16 v[224:239], v[32:35], v[120:123], v[224:239]
    ds_read_b64_tr_b16 v[28:29], v12 offset:24576
    ds_read_b64_tr_b16 v[30:31], v12 offset:26624
    s_waitcnt lgkmcnt(14)
    ds_read_b128 v[152:155], v42 offset:8192
    ds_read_b128 v[156:159], v43 offset:8192
    v_mfma_f32_32x32x16_bf16 v[240:255], v[36:39], v[120:123], v[240:255]
    v_subrev_u32 v9, 0x20000, v9
    ds_read_b64_tr_b16 v[32:33], v9 offset:16384
    ds_read_b64_tr_b16 v[34:35], v9 offset:18432
    s_waitcnt lgkmcnt(15)
    v_mfma_f32_32x32x16_bf16 v[192:207], v[16:19], v[124:127], v[192:207]
    v_subrev_u32 v10, 0x20000, v10
    ds_read_b64_tr_b16 v[36:37], v10 offset:16384
    ds_read_b64_tr_b16 v[38:39], v10 offset:18432
    s_waitcnt lgkmcnt(15)
    v_mfma_f32_32x32x16_bf16 v[208:223], v[20:23], v[124:127], v[208:223]
    v_subrev_u32 v11, 0x20000, v11
    ds_read_b64_tr_b16 v[16:17], v11 offset:16384
    ds_read_b64_tr_b16 v[18:19], v11 offset:18432
    s_waitcnt lgkmcnt(13)
    v_mfma_f32_32x32x16_bf16 v[224:239], v[24:27], v[124:127], v[224:239]
    v_subrev_u32 v12, 0x20000, v12
    ds_read_b64_tr_b16 v[20:21], v12 offset:16384
    ds_read_b64_tr_b16 v[22:23], v12 offset:18432
    s_waitcnt lgkmcnt(10)
    v_mfma_f32_32x32x16_bf16 v[240:255], v[28:31], v[124:127], v[240:255]
    ds_read_b64_tr_b16 v[24:25], v9 offset:24576
    ds_read_b64_tr_b16 v[26:27], v9 offset:26624
    s_waitcnt lgkmcnt(8)
    s_barrier
    v_mfma_f32_32x32x16_bf16 v[192:207], v[32:35], v[128:131], v[192:207]
    ds_read_b64_tr_b16 v[28:29], v10 offset:24576
    ds_read_b64_tr_b16 v[30:31], v10 offset:26624
    s_waitcnt lgkmcnt(8)
    v_mfma_f32_32x32x16_bf16 v[208:223], v[36:39], v[128:131], v[208:223]
    ds_read_b64_tr_b16 v[32:33], v11 offset:24576
    ds_read_b64_tr_b16 v[34:35], v11 offset:26624
    s_waitcnt lgkmcnt(8)
    v_mfma_f32_32x32x16_bf16 v[224:239], v[16:19], v[128:131], v[224:239]
    ds_read_b64_tr_b16 v[36:37], v12 offset:24576
    ds_read_b64_tr_b16 v[38:39], v12 offset:26624
    s_waitcnt lgkmcnt(8)
    v_mfma_f32_32x32x16_bf16 v[240:255], v[20:23], v[128:131], v[240:255]
    ds_read_b64_tr_b16 v[16:17], v9 offset:32768
    ds_read_b64_tr_b16 v[18:19], v9 offset:34816
    s_waitcnt lgkmcnt(8)
    v_mfma_f32_32x32x16_bf16 v[192:207], v[24:27], v[132:135], v[192:207]
    ds_read_b64_tr_b16 v[20:21], v10 offset:32768
    ds_read_b64_tr_b16 v[22:23], v10 offset:34816
    s_waitcnt lgkmcnt(8)
    v_mfma_f32_32x32x16_bf16 v[208:223], v[28:31], v[132:135], v[208:223]
    ds_read_b64_tr_b16 v[24:25], v11 offset:32768
    ds_read_b64_tr_b16 v[26:27], v11 offset:34816
    s_waitcnt lgkmcnt(8)
    v_mfma_f32_32x32x16_bf16 v[224:239], v[32:35], v[132:135], v[224:239]
    ds_read_b64_tr_b16 v[28:29], v12 offset:32768
    ds_read_b64_tr_b16 v[30:31], v12 offset:34816
    s_waitcnt lgkmcnt(8)
    v_mfma_f32_32x32x16_bf16 v[240:255], v[36:39], v[132:135], v[240:255]
    ds_read_b64_tr_b16 v[32:33], v9 offset:40960
    ds_read_b64_tr_b16 v[34:35], v9 offset:43008
    s_waitcnt lgkmcnt(8)
    s_barrier
    v_mfma_f32_32x32x16_bf16 v[192:207], v[16:19], v[136:139], v[192:207]
    ds_read_b64_tr_b16 v[36:37], v10 offset:40960
    ds_read_b64_tr_b16 v[38:39], v10 offset:43008
    s_waitcnt lgkmcnt(8)
    v_mfma_f32_32x32x16_bf16 v[208:223], v[20:23], v[136:139], v[208:223]
    ds_read_b64_tr_b16 v[16:17], v11 offset:40960
    ds_read_b64_tr_b16 v[18:19], v11 offset:43008
    s_waitcnt lgkmcnt(8)
    v_mfma_f32_32x32x16_bf16 v[224:239], v[24:27], v[136:139], v[224:239]
    ds_read_b64_tr_b16 v[20:21], v12 offset:40960
    ds_read_b64_tr_b16 v[22:23], v12 offset:43008
    s_waitcnt lgkmcnt(8)
    v_mfma_f32_32x32x16_bf16 v[240:255], v[28:31], v[136:139], v[240:255]
    ds_read_b64_tr_b16 v[24:25], v9 offset:49152
    ds_read_b64_tr_b16 v[26:27], v9 offset:51200
    s_waitcnt lgkmcnt(8)
    v_mfma_f32_32x32x16_bf16 v[192:207], v[32:35], v[140:143], v[192:207]
    ds_read_b64_tr_b16 v[28:29], v10 offset:49152
    ds_read_b64_tr_b16 v[30:31], v10 offset:51200
    s_waitcnt lgkmcnt(8)
    v_mfma_f32_32x32x16_bf16 v[208:223], v[36:39], v[140:143], v[208:223]
    ds_read_b64_tr_b16 v[32:33], v11 offset:49152
    ds_read_b64_tr_b16 v[34:35], v11 offset:51200
    s_waitcnt lgkmcnt(8)
    v_mfma_f32_32x32x16_bf16 v[224:239], v[16:19], v[140:143], v[224:239]
    ds_read_b64_tr_b16 v[36:37], v12 offset:49152
    ds_read_b64_tr_b16 v[38:39], v12 offset:51200
    s_waitcnt lgkmcnt(8)
    v_mfma_f32_32x32x16_bf16 v[240:255], v[20:23], v[140:143], v[240:255]
    ds_read_b64_tr_b16 v[16:17], v9 offset:57344
    ds_read_b64_tr_b16 v[18:19], v9 offset:59392
    s_waitcnt lgkmcnt(8)
    s_barrier
    v_mfma_f32_32x32x16_bf16 v[192:207], v[24:27], v[144:147], v[192:207]
    ds_read_b64_tr_b16 v[20:21], v10 offset:57344
    ds_read_b64_tr_b16 v[22:23], v10 offset:59392
    s_waitcnt lgkmcnt(8)
    v_mfma_f32_32x32x16_bf16 v[208:223], v[28:31], v[144:147], v[208:223]
    ds_read_b64_tr_b16 v[24:25], v11 offset:57344
    ds_read_b64_tr_b16 v[26:27], v11 offset:59392
    s_waitcnt lgkmcnt(8)
    v_mfma_f32_32x32x16_bf16 v[224:239], v[32:35], v[144:147], v[224:239]
    ds_read_b64_tr_b16 v[28:29], v12 offset:57344
    ds_read_b64_tr_b16 v[30:31], v12 offset:59392
    s_waitcnt lgkmcnt(8)
    v_mfma_f32_32x32x16_bf16 v[240:255], v[36:39], v[144:147], v[240:255]
    v_add_u32 v9, 0x10000, v9
    ds_read_b64_tr_b16 v[32:33], v9 offset:0
    ds_read_b64_tr_b16 v[34:35], v9 offset:2048
    s_waitcnt lgkmcnt(8)
    v_mfma_f32_32x32x16_bf16 v[192:207], v[16:19], v[148:151], v[192:207]
    v_add_u32 v10, 0x10000, v10
    ds_read_b64_tr_b16 v[36:37], v10 offset:0
    ds_read_b64_tr_b16 v[38:39], v10 offset:2048
    s_waitcnt lgkmcnt(8)
    v_mfma_f32_32x32x16_bf16 v[208:223], v[20:23], v[148:151], v[208:223]
    v_add_u32 v11, 0x10000, v11
    ds_read_b64_tr_b16 v[16:17], v11 offset:0
    ds_read_b64_tr_b16 v[18:19], v11 offset:2048
    s_waitcnt lgkmcnt(8)
    v_mfma_f32_32x32x16_bf16 v[224:239], v[24:27], v[148:151], v[224:239]
    v_add_u32 v12, 0x10000, v12
    ds_read_b64_tr_b16 v[20:21], v12 offset:0
    ds_read_b64_tr_b16 v[22:23], v12 offset:2048
    s_waitcnt lgkmcnt(8)
    v_mfma_f32_32x32x16_bf16 v[240:255], v[28:31], v[148:151], v[240:255]
    ds_read_b64_tr_b16 v[24:25], v9 offset:8192
    ds_read_b64_tr_b16 v[26:27], v9 offset:10240
    s_waitcnt lgkmcnt(8)
    s_barrier
    v_mfma_f32_32x32x16_bf16 v[192:207], v[32:35], v[152:155], v[192:207]
    ds_read_b64_tr_b16 v[28:29], v10 offset:8192
    ds_read_b64_tr_b16 v[30:31], v10 offset:10240
    s_waitcnt lgkmcnt(8)
    v_add_u32 v40, 0x10000, v40
    ds_read_b128 v[160:163], v40 offset:16384
    v_add_u32 v41, 0x10000, v41
    ds_read_b128 v[164:167], v41 offset:16384
    v_add_u32 v42, 0x10000, v42
    ds_read_b128 v[168:171], v42 offset:16384
    v_mfma_f32_32x32x16_bf16 v[208:223], v[36:39], v[152:155], v[208:223]
    ds_read_b64_tr_b16 v[32:33], v11 offset:8192
    ds_read_b64_tr_b16 v[34:35], v11 offset:10240
    s_waitcnt lgkmcnt(11)
    v_add_u32 v43, 0x10000, v43
    ds_read_b128 v[172:175], v43 offset:16384
    v_mfma_f32_32x32x16_bf16 v[224:239], v[16:19], v[152:155], v[224:239]
    ds_read_b64_tr_b16 v[36:37], v12 offset:8192
    ds_read_b64_tr_b16 v[38:39], v12 offset:10240
    s_waitcnt lgkmcnt(12)
    v_mfma_f32_32x32x16_bf16 v[240:255], v[20:23], v[152:155], v[240:255]
    ds_read_b64_tr_b16 v[16:17], v9 offset:32768
    ds_read_b64_tr_b16 v[18:19], v9 offset:34816
    s_waitcnt lgkmcnt(12)
    v_mfma_f32_32x32x16_bf16 v[192:207], v[24:27], v[156:159], v[192:207]
    ds_read_b64_tr_b16 v[20:21], v9 offset:40960
    ds_read_b64_tr_b16 v[22:23], v9 offset:43008
    s_waitcnt lgkmcnt(12)
    v_mfma_f32_32x32x16_bf16 v[208:223], v[28:31], v[156:159], v[208:223]
    ds_read_b64_tr_b16 v[24:25], v9 offset:49152
    ds_read_b64_tr_b16 v[26:27], v9 offset:51200
    s_waitcnt lgkmcnt(9)
    v_mfma_f32_32x32x16_bf16 v[224:239], v[32:35], v[156:159], v[224:239]
    ds_read_b64_tr_b16 v[28:29], v9 offset:57344
    ds_read_b64_tr_b16 v[30:31], v9 offset:59392
    s_waitcnt lgkmcnt(8)
    v_mfma_f32_32x32x16_bf16 v[240:255], v[36:39], v[156:159], v[240:255]
    ds_read_b64_tr_b16 v[32:33], v10 offset:32768
    ds_read_b64_tr_b16 v[34:35], v10 offset:34816
    s_waitcnt lgkmcnt(8)
    s_barrier
    v_mfma_f32_32x32x16_bf16 v[192:207], v[16:19], v[160:163], v[192:207]
    ds_read_b64_tr_b16 v[36:37], v10 offset:40960
    ds_read_b64_tr_b16 v[38:39], v10 offset:43008
    s_waitcnt lgkmcnt(8)
    v_mfma_f32_32x32x16_bf16 v[192:207], v[20:23], v[164:167], v[192:207]
    ds_read_b64_tr_b16 v[16:17], v10 offset:49152
    ds_read_b64_tr_b16 v[18:19], v10 offset:51200
    s_waitcnt lgkmcnt(8)
    v_mfma_f32_32x32x16_bf16 v[192:207], v[24:27], v[168:171], v[192:207]
    ds_read_b64_tr_b16 v[20:21], v10 offset:57344
    ds_read_b64_tr_b16 v[22:23], v10 offset:59392
    s_waitcnt lgkmcnt(8)
    v_mfma_f32_32x32x16_bf16 v[192:207], v[28:31], v[172:175], v[192:207]
    ds_read_b64_tr_b16 v[24:25], v11 offset:32768
    ds_read_b64_tr_b16 v[26:27], v11 offset:34816
    s_waitcnt lgkmcnt(8)
    v_mfma_f32_32x32x16_bf16 v[208:223], v[32:35], v[160:163], v[208:223]
    ds_read_b64_tr_b16 v[28:29], v11 offset:40960
    ds_read_b64_tr_b16 v[30:31], v11 offset:43008
    s_waitcnt lgkmcnt(8)
    v_mfma_f32_32x32x16_bf16 v[208:223], v[36:39], v[164:167], v[208:223]
    ds_read_b64_tr_b16 v[32:33], v11 offset:49152
    ds_read_b64_tr_b16 v[34:35], v11 offset:51200
    s_waitcnt lgkmcnt(8)
    v_mfma_f32_32x32x16_bf16 v[208:223], v[16:19], v[168:171], v[208:223]
    ds_read_b64_tr_b16 v[36:37], v11 offset:57344
    ds_read_b64_tr_b16 v[38:39], v11 offset:59392
    s_waitcnt lgkmcnt(8)
    v_cvt_pk_bf16_f32 v192, v192, v193
    v_cvt_pk_bf16_f32 v193, v194, v195
    v_cvt_pk_bf16_f32 v194, v196, v197
    v_mfma_f32_32x32x16_bf16 v[208:223], v[20:23], v[172:175], v[208:223]
    ds_read_b64_tr_b16 v[16:17], v12 offset:32768
    ds_read_b64_tr_b16 v[18:19], v12 offset:34816
    s_waitcnt lgkmcnt(8)
    v_cvt_pk_bf16_f32 v195, v198, v199
    ds_write_b128 v13, v[192:195] offset:0
    v_cvt_pk_bf16_f32 v200, v200, v201
    s_barrier
    v_mfma_f32_32x32x16_bf16 v[224:239], v[24:27], v[160:163], v[224:239]
    ds_read_b64_tr_b16 v[20:21], v12 offset:40960
    ds_read_b64_tr_b16 v[22:23], v12 offset:43008
    s_waitcnt lgkmcnt(9)
    v_cvt_pk_bf16_f32 v201, v202, v203
    v_cvt_pk_bf16_f32 v202, v204, v205
    v_cvt_pk_bf16_f32 v203, v206, v207
    v_mfma_f32_32x32x16_bf16 v[224:239], v[28:31], v[164:167], v[224:239]
    ds_read_b64_tr_b16 v[24:25], v12 offset:49152
    ds_read_b64_tr_b16 v[26:27], v12 offset:51200
    s_waitcnt lgkmcnt(9)
    ds_write_b128 v13, v[200:203] offset:1024
    v_mfma_f32_32x32x16_bf16 v[224:239], v[32:35], v[168:171], v[224:239]
    ds_read_b64_tr_b16 v[28:29], v12 offset:57344
    ds_read_b64_tr_b16 v[30:31], v12 offset:59392
    s_waitcnt lgkmcnt(10)
    v_cvt_pk_bf16_f32 v208, v208, v209
    v_cvt_pk_bf16_f32 v209, v210, v211
    v_cvt_pk_bf16_f32 v210, v212, v213
    v_cvt_pk_bf16_f32 v211, v214, v215
    v_mfma_f32_32x32x16_bf16 v[224:239], v[36:39], v[172:175], v[224:239]
    v_add_u32 v1, 0x20000, v1
    ds_read_b128 v[32:35], v1 offset:0
    s_waitcnt lgkmcnt(9)
    ds_write_b128 v13, v[208:211] offset:2048
    v_cvt_pk_bf16_f32 v216, v216, v217
    v_cvt_pk_bf16_f32 v217, v218, v219
    v_cvt_pk_bf16_f32 v218, v220, v221
    v_mfma_f32_32x32x16_bf16 v[240:255], v[16:19], v[160:163], v[240:255]
    v_add_u32 v2, 0x20000, v2
    ds_read_b128 v[36:39], v2 offset:0
    s_waitcnt lgkmcnt(8)
    v_cvt_pk_bf16_f32 v219, v222, v223
    ds_write_b128 v13, v[216:219] offset:3072
    v_mfma_f32_32x32x16_bf16 v[240:255], v[20:23], v[164:167], v[240:255]
    v_add_u32 v3, 0x20000, v3
    ds_read_b128 v[16:19], v3 offset:0
    s_waitcnt lgkmcnt(8)
    v_mfma_f32_32x32x16_bf16 v[240:255], v[24:27], v[168:171], v[240:255]
    v_add_u32 v4, 0x20000, v4
    ds_read_b128 v[20:23], v4 offset:0
    s_waitcnt lgkmcnt(6)
    v_cvt_pk_bf16_f32 v224, v224, v225
    v_cvt_pk_bf16_f32 v225, v226, v227
    v_cvt_pk_bf16_f32 v226, v228, v229
    v_cvt_pk_bf16_f32 v227, v230, v231
    ds_write_b128 v13, v[224:227] offset:4096
    v_mfma_f32_32x32x16_bf16 v[240:255], v[28:31], v[172:175], v[240:255]
    v_add_u32 v5, 0x20000, v5
    ds_read_b128 v[24:27], v5 offset:0
    s_waitcnt lgkmcnt(7)
    v_cvt_pk_bf16_f32 v232, v232, v233
    v_cvt_pk_bf16_f32 v233, v234, v235
    v_cvt_pk_bf16_f32 v234, v236, v237
    v_cvt_pk_bf16_f32 v235, v238, v239
    ds_write_b128 v13, v[232:235] offset:5120
    s_nop 3
    v_cvt_pk_bf16_f32 v240, v240, v241
    v_cvt_pk_bf16_f32 v241, v242, v243
    v_cvt_pk_bf16_f32 v242, v244, v245
    v_cvt_pk_bf16_f32 v243, v246, v247
    ds_write_b128 v13, v[240:243] offset:6144
    v_cvt_pk_bf16_f32 v248, v248, v249
    v_cvt_pk_bf16_f32 v249, v250, v251
    v_cvt_pk_bf16_f32 v250, v252, v253
    v_cvt_pk_bf16_f32 v251, v254, v255
    ds_write_b128 v13, v[248:251] offset:7168
    v_lshl_add_u32 v13, v0, 4, s14
    s_waitcnt lgkmcnt(0)
    s_barrier
    ds_read_b128 v[192:195], v13 offset:0
    ds_read_b128 v[196:199], v13 offset:1024
    ds_read_b128 v[200:203], v13 offset:2048
    ds_read_b128 v[204:207], v13 offset:3072
    ds_read_b128 v[208:211], v13 offset:4096
    ds_read_b128 v[212:215], v13 offset:5120
    ds_read_b128 v[216:219], v13 offset:6144
    ds_read_b128 v[220:223], v13 offset:7168
    ds_read_b128 v[224:227], v13 offset:8192
    ds_read_b128 v[228:231], v13 offset:9216
    ds_read_b128 v[232:235], v13 offset:10240
    ds_read_b128 v[236:239], v13 offset:11264
    ds_read_b128 v[240:243], v13 offset:12288
    ds_read_b128 v[244:247], v13 offset:13312
    ds_read_b128 v[248:251], v13 offset:14336
    ds_read_b128 v[252:255], v13 offset:15360
    s_waitcnt lgkmcnt(15)
    v_mfma_f32_32x32x16_bf16 v[64:79], v[32:35], v[192:195], 0
    v_add_u32 v6, 0x20000, v6
    ds_read_b128 v[28:31], v6 offset:0
    s_waitcnt lgkmcnt(15)
    v_mfma_f32_32x32x16_bf16 v[64:79], v[36:39], v[196:199], v[64:79]
    v_add_u32 v7, 0x20000, v7
    ds_read_b128 v[32:35], v7 offset:0
    s_waitcnt lgkmcnt(15)
    v_mfma_f32_32x32x16_bf16 v[64:79], v[16:19], v[200:203], v[64:79]
    v_add_u32 v8, 0x20000, v8
    ds_read_b128 v[36:39], v8 offset:0
    s_waitcnt lgkmcnt(15)
    v_lshrrev_b32 v48, 5, v0
    v_bfe_u32 v49, v0, 2, 2
    v_lshl_add_u32 v48, v48, 2, v49
    v_bfe_u32 v50, v0, 4, 1
    v_mfma_f32_32x32x16_bf16 v[64:79], v[20:23], v[204:207], v[64:79]
    ds_read_b128 v[16:19], v1 offset:16384
    s_waitcnt lgkmcnt(15)
    v_lshlrev_b32 v50, 5, v50
    v_lshl_add_u32 v15, v48, 8, v50
    v_and_b32 v11, 3, v0
    v_lshl_add_u32 v15, v11, 3, v15
    v_mfma_f32_32x32x16_bf16 v[64:79], v[24:27], v[208:211], v[64:79]
    ds_read_b128 v[20:23], v2 offset:16384
    s_waitcnt lgkmcnt(4)
    s_lshl_b32 s10, s8, 1
    v_xor_b32 v11, s10, v49
    v_lshl_add_u32 v9, v11, 6, v15
    v_xor_b32 v11, 1, v11
    v_mfma_f32_32x32x16_bf16 v[64:79], v[28:31], v[212:215], v[64:79]
    ds_read_b128 v[24:27], v3 offset:16384
    s_waitcnt lgkmcnt(4)
    v_lshl_add_u32 v10, v11, 6, v15
    v_lshl_add_u32 v15, v48, 7, v50
    v_lshrrev_b32 v49, 1, v49
    v_xor_b32 v49, s8, v49
    v_mfma_f32_32x32x16_bf16 v[64:79], v[32:35], v[216:219], v[64:79]
    ds_read_b128 v[28:31], v4 offset:16384
    s_waitcnt lgkmcnt(4)
    v_lshl_add_u32 v15, v49, 6, v15
    v_and_b32 v49, 1, v0
    v_lshl_add_u32 v15, v49, 4, v15
    v_bfe_u32 v49, v0, 1, 1
    v_mfma_f32_32x32x16_bf16 v[64:79], v[36:39], v[220:223], v[64:79]
    ds_read_b128 v[32:35], v5 offset:16384
    s_waitcnt lgkmcnt(4)
    v_lshl_add_u32 v11, v49, 3, v15
    s_lshl_b32 s10, s8, 12
    s_lshl_b32 s11, s9, 11
    s_add_u32 s10, s10, s11
    s_barrier
    v_mfma_f32_32x32x16_bf16 v[64:79], v[16:19], v[224:227], v[64:79]
    ds_read_b128 v[36:39], v6 offset:16384
    s_waitcnt lgkmcnt(4)
    v_lshl_add_u32 v14, v0, 4, s10
    v_lshl_add_u32 v12, v0, 4, s11
    s_waitcnt vmcnt(0)
    v_mfma_f32_32x32x16_bf16 v[64:79], v[20:23], v[228:231], v[64:79]
    ds_read_b128 v[16:19], v7 offset:16384
    s_waitcnt lgkmcnt(4)
    v_mfma_f32_32x32x16_bf16 v[64:79], v[24:27], v[232:235], v[64:79]
    ds_read_b128 v[20:23], v8 offset:16384
    s_waitcnt lgkmcnt(4)
    v_mfma_f32_32x32x16_bf16 v[64:79], v[28:31], v[236:239], v[64:79]
    v_subrev_u32 v1, 0x20000, v1
    ds_read_b128 v[24:27], v1 offset:0
    s_waitcnt lgkmcnt(4)
    v_mfma_f32_32x32x16_bf16 v[64:79], v[32:35], v[240:243], v[64:79]
    v_subrev_u32 v2, 0x20000, v2
    ds_read_b128 v[28:31], v2 offset:0
    s_waitcnt lgkmcnt(4)
    v_mfma_f32_32x32x16_bf16 v[64:79], v[36:39], v[244:247], v[64:79]
    v_subrev_u32 v3, 0x20000, v3
    ds_read_b128 v[32:35], v3 offset:0
    s_waitcnt lgkmcnt(4)
    v_mfma_f32_32x32x16_bf16 v[64:79], v[16:19], v[248:251], v[64:79]
    v_subrev_u32 v4, 0x20000, v4
    ds_read_b128 v[36:39], v4 offset:0
    s_waitcnt lgkmcnt(4)
    v_mfma_f32_32x32x16_bf16 v[64:79], v[20:23], v[252:255], v[64:79]
    v_subrev_u32 v5, 0x20000, v5
    ds_read_b128 v[16:19], v5 offset:0
    s_waitcnt lgkmcnt(4)
    s_barrier
    v_mfma_f32_32x32x16_bf16 v[80:95], v[24:27], v[192:195], 0
    v_subrev_u32 v6, 0x20000, v6
    ds_read_b128 v[20:23], v6 offset:0
    s_waitcnt lgkmcnt(4)
    v_mfma_f32_32x32x16_bf16 v[80:95], v[28:31], v[196:199], v[80:95]
    v_subrev_u32 v7, 0x20000, v7
    ds_read_b128 v[24:27], v7 offset:0
    s_waitcnt lgkmcnt(4)
    v_mfma_f32_32x32x16_bf16 v[80:95], v[32:35], v[200:203], v[80:95]
    v_subrev_u32 v8, 0x20000, v8
    ds_read_b128 v[28:31], v8 offset:0
    s_waitcnt lgkmcnt(4)
    v_max_f32 v47, v64, v65
    v_max3_f32 v47, v66, v67, v47
    v_max3_f32 v47, v68, v69, v47
    v_max3_f32 v47, v70, v71, v47
    v_max3_f32 v47, v72, v73, v47
    v_mfma_f32_32x32x16_bf16 v[80:95], v[36:39], v[204:207], v[80:95]
    ds_read_b128 v[32:35], v1 offset:49152
    s_waitcnt lgkmcnt(4)
    v_max3_f32 v47, v74, v75, v47
    v_max3_f32 v47, v76, v77, v47
    v_max3_f32 v47, v78, v79, v47
    v_mul_f32 v40, s12, v47
    v_fma_f32 v64, v64, s12, -v40
    v_mfma_f32_32x32x16_bf16 v[80:95], v[16:19], v[208:211], v[80:95]
    ds_read_b128 v[36:39], v2 offset:49152
    s_waitcnt lgkmcnt(4)
    v_fma_f32 v65, v65, s12, -v40
    v_exp_f32 v64, v64
    v_fma_f32 v66, v66, s12, -v40
    v_mfma_f32_32x32x16_bf16 v[80:95], v[20:23], v[212:215], v[80:95]
    ds_read_b128 v[16:19], v3 offset:49152
    s_waitcnt lgkmcnt(4)
    v_exp_f32 v65, v65
    v_mov_b32 v60, v64
    v_fma_f32 v67, v67, s12, -v40
    v_mfma_f32_32x32x16_bf16 v[80:95], v[24:27], v[216:219], v[80:95]
    ds_read_b128 v[20:23], v4 offset:49152
    s_waitcnt lgkmcnt(4)
    v_exp_f32 v66, v66
    v_add_f32 v60, v60, v65
    v_fma_f32 v68, v68, s12, -v40
    v_mfma_f32_32x32x16_bf16 v[80:95], v[28:31], v[220:223], v[80:95]
    ds_read_b128 v[24:27], v5 offset:49152
    s_waitcnt lgkmcnt(4)
    v_exp_f32 v67, v67
    v_add_f32 v60, v60, v66
    v_fma_f32 v69, v69, s12, -v40
    s_barrier
    v_mfma_f32_32x32x16_bf16 v[80:95], v[32:35], v[224:227], v[80:95]
    ds_read_b128 v[28:31], v6 offset:49152
    s_waitcnt lgkmcnt(4)
    v_exp_f32 v68, v68
    v_add_f32 v60, v60, v67
    v_fma_f32 v70, v70, s12, -v40
    v_mfma_f32_32x32x16_bf16 v[80:95], v[36:39], v[228:231], v[80:95]
    ds_read_b128 v[32:35], v7 offset:49152
    s_waitcnt lgkmcnt(4)
    v_exp_f32 v69, v69
    v_add_f32 v60, v60, v68
    v_fma_f32 v71, v71, s12, -v40
    v_mfma_f32_32x32x16_bf16 v[80:95], v[16:19], v[232:235], v[80:95]
    ds_read_b128 v[36:39], v8 offset:49152
    s_waitcnt lgkmcnt(4)
    v_exp_f32 v70, v70
    v_add_f32 v60, v60, v69
    v_fma_f32 v72, v72, s12, -v40
    v_mfma_f32_32x32x16_bf16 v[80:95], v[20:23], v[236:239], v[80:95]
    v_add_u32 v1, 0x10000, v1
    ds_read_b128 v[16:19], v1 offset:0
    s_waitcnt lgkmcnt(4)
    v_exp_f32 v71, v71
    v_add_f32 v60, v60, v70
    v_fma_f32 v73, v73, s12, -v40
    v_mfma_f32_32x32x16_bf16 v[80:95], v[24:27], v[240:243], v[80:95]
    v_add_u32 v2, 0x10000, v2
    ds_read_b128 v[20:23], v2 offset:0
    s_waitcnt lgkmcnt(4)
    v_exp_f32 v72, v72
    v_add_f32 v60, v60, v71
    v_fma_f32 v74, v74, s12, -v40
    v_mfma_f32_32x32x16_bf16 v[80:95], v[28:31], v[244:247], v[80:95]
    v_add_u32 v3, 0x10000, v3
    ds_read_b128 v[24:27], v3 offset:0
    s_waitcnt lgkmcnt(4)
    v_exp_f32 v73, v73
    v_add_f32 v60, v60, v72
    v_fma_f32 v75, v75, s12, -v40
    v_mfma_f32_32x32x16_bf16 v[80:95], v[32:35], v[248:251], v[80:95]
    v_add_u32 v4, 0x10000, v4
    ds_read_b128 v[28:31], v4 offset:0
    s_waitcnt lgkmcnt(4)
    v_exp_f32 v74, v74
    v_add_f32 v60, v60, v73
    v_fma_f32 v76, v76, s12, -v40
    v_mfma_f32_32x32x16_bf16 v[80:95], v[36:39], v[252:255], v[80:95]
    v_add_u32 v5, 0x10000, v5
    ds_read_b128 v[32:35], v5 offset:0
    s_waitcnt lgkmcnt(4)
    v_exp_f32 v75, v75
    v_add_f32 v60, v60, v74
    v_fma_f32 v77, v77, s12, -v40
    s_barrier
    v_mfma_f32_32x32x16_bf16 v[96:111], v[16:19], v[192:195], 0
    v_add_u32 v6, 0x10000, v6
    ds_read_b128 v[36:39], v6 offset:0
    s_waitcnt lgkmcnt(4)
    v_exp_f32 v76, v76
    v_add_f32 v60, v60, v75
    v_fma_f32 v78, v78, s12, -v40
    v_mfma_f32_32x32x16_bf16 v[96:111], v[20:23], v[196:199], v[96:111]
    v_add_u32 v7, 0x10000, v7
    ds_read_b128 v[16:19], v7 offset:0
    s_waitcnt lgkmcnt(4)
    v_exp_f32 v77, v77
    v_add_f32 v60, v60, v76
    v_fma_f32 v79, v79, s12, -v40
    v_mfma_f32_32x32x16_bf16 v[96:111], v[24:27], v[200:203], v[96:111]
    v_add_u32 v8, 0x10000, v8
    ds_read_b128 v[20:23], v8 offset:0
    s_waitcnt lgkmcnt(4)
    v_exp_f32 v78, v78
    v_add_f32 v60, v60, v77
    v_exp_f32 v79, v79
    v_mfma_f32_32x32x16_bf16 v[96:111], v[28:31], v[204:207], v[96:111]
    ds_read_b128 v[24:27], v1 offset:16384
    s_waitcnt lgkmcnt(4)
    v_add_f32 v60, v60, v78
    v_add_f32 v60, v60, v79
    v_max3_f32 v47, v80, v81, v47
    v_max3_f32 v47, v82, v83, v47
    v_max3_f32 v47, v84, v85, v47
    v_mfma_f32_32x32x16_bf16 v[96:111], v[32:35], v[208:211], v[96:111]
    ds_read_b128 v[28:31], v2 offset:16384
    s_waitcnt lgkmcnt(4)
    v_max3_f32 v47, v86, v87, v47
    v_max3_f32 v47, v88, v89, v47
    v_max3_f32 v47, v90, v91, v47
    v_max3_f32 v47, v92, v93, v47
    v_max3_f32 v47, v94, v95, v47
    v_mfma_f32_32x32x16_bf16 v[96:111], v[36:39], v[212:215], v[96:111]
    ds_read_b128 v[32:35], v3 offset:16384
    s_waitcnt lgkmcnt(4)
    v_mul_f32 v41, s12, v47
    v_sub_f32 v62, v40, v41
    v_exp_f32 v62, v62
    s_nop 0
    v_mul_f32 v60, v60, v62
    v_mfma_f32_32x32x16_bf16 v[96:111], v[16:19], v[216:219], v[96:111]
    ds_read_b128 v[36:39], v4 offset:16384
    s_waitcnt lgkmcnt(4)
    v_fma_f32 v80, v80, s12, -v41
    v_fma_f32 v81, v81, s12, -v41
    v_exp_f32 v80, v80
    v_fma_f32 v82, v82, s12, -v41
    v_mfma_f32_32x32x16_bf16 v[96:111], v[20:23], v[220:223], v[96:111]
    ds_read_b128 v[16:19], v5 offset:16384
    s_waitcnt lgkmcnt(4)
    v_exp_f32 v81, v81
    v_add_f32 v60, v60, v80
    v_fma_f32 v83, v83, s12, -v41
    s_barrier
    v_mfma_f32_32x32x16_bf16 v[96:111], v[24:27], v[224:227], v[96:111]
    ds_read_b128 v[20:23], v6 offset:16384
    s_waitcnt lgkmcnt(4)
    v_exp_f32 v82, v82
    v_add_f32 v60, v60, v81
    v_fma_f32 v84, v84, s12, -v41
    v_mfma_f32_32x32x16_bf16 v[96:111], v[28:31], v[228:231], v[96:111]
    ds_read_b128 v[24:27], v7 offset:16384
    s_waitcnt lgkmcnt(4)
    v_exp_f32 v83, v83
    v_add_f32 v60, v60, v82
    v_fma_f32 v85, v85, s12, -v41
    v_mfma_f32_32x32x16_bf16 v[96:111], v[32:35], v[232:235], v[96:111]
    ds_read_b128 v[28:31], v8 offset:16384
    s_waitcnt lgkmcnt(4)
    v_exp_f32 v84, v84
    v_add_f32 v60, v60, v83
    v_fma_f32 v86, v86, s12, -v41
    v_mfma_f32_32x32x16_bf16 v[96:111], v[36:39], v[236:239], v[96:111]
    ds_read_b128 v[32:35], v1 offset:32768
    s_waitcnt lgkmcnt(4)
    v_exp_f32 v85, v85
    v_add_f32 v60, v60, v84
    v_fma_f32 v87, v87, s12, -v41
    v_mfma_f32_32x32x16_bf16 v[96:111], v[16:19], v[240:243], v[96:111]
    ds_read_b128 v[36:39], v2 offset:32768
    s_waitcnt lgkmcnt(4)
    v_exp_f32 v86, v86
    v_add_f32 v60, v60, v85
    v_fma_f32 v88, v88, s12, -v41
    v_mfma_f32_32x32x16_bf16 v[96:111], v[20:23], v[244:247], v[96:111]
    ds_read_b128 v[16:19], v3 offset:32768
    s_waitcnt lgkmcnt(4)
    v_exp_f32 v87, v87
    v_add_f32 v60, v60, v86
    v_fma_f32 v89, v89, s12, -v41
    v_mfma_f32_32x32x16_bf16 v[96:111], v[24:27], v[248:251], v[96:111]
    ds_read_b128 v[20:23], v4 offset:32768
    s_waitcnt lgkmcnt(4)
    v_exp_f32 v88, v88
    v_add_f32 v60, v60, v87
    v_fma_f32 v90, v90, s12, -v41
    v_mfma_f32_32x32x16_bf16 v[96:111], v[28:31], v[252:255], v[96:111]
    ds_read_b128 v[24:27], v5 offset:32768
    s_waitcnt lgkmcnt(4)
    v_exp_f32 v89, v89
    v_add_f32 v60, v60, v88
    v_fma_f32 v91, v91, s12, -v41
    s_barrier
    v_mfma_f32_32x32x16_bf16 v[112:127], v[32:35], v[192:195], 0
    ds_read_b128 v[28:31], v6 offset:32768
    s_waitcnt lgkmcnt(4)
    v_exp_f32 v90, v90
    v_add_f32 v60, v60, v89
    v_fma_f32 v92, v92, s12, -v41
    v_mfma_f32_32x32x16_bf16 v[112:127], v[36:39], v[196:199], v[112:127]
    ds_read_b128 v[32:35], v7 offset:32768
    s_waitcnt lgkmcnt(4)
    v_exp_f32 v91, v91
    v_add_f32 v60, v60, v90
    v_fma_f32 v93, v93, s12, -v41
    v_mfma_f32_32x32x16_bf16 v[112:127], v[16:19], v[200:203], v[112:127]
    ds_read_b128 v[36:39], v8 offset:32768
    s_waitcnt lgkmcnt(4)
    v_exp_f32 v92, v92
    v_add_f32 v60, v60, v91
    v_fma_f32 v94, v94, s12, -v41
    v_mfma_f32_32x32x16_bf16 v[112:127], v[20:23], v[204:207], v[112:127]
    ds_read_b128 v[16:19], v1 offset:49152
    s_waitcnt lgkmcnt(4)
    v_exp_f32 v93, v93
    v_add_f32 v60, v60, v92
    v_fma_f32 v95, v95, s12, -v41
    v_exp_f32 v94, v94
    v_mfma_f32_32x32x16_bf16 v[112:127], v[24:27], v[208:211], v[112:127]
    ds_read_b128 v[20:23], v2 offset:49152
    s_waitcnt lgkmcnt(4)
    v_add_f32 v60, v60, v93
    v_exp_f32 v95, v95
    v_add_f32 v60, v60, v94
    v_add_f32 v60, v60, v95
    v_mfma_f32_32x32x16_bf16 v[112:127], v[28:31], v[212:215], v[112:127]
    ds_read_b128 v[24:27], v3 offset:49152
    s_waitcnt lgkmcnt(4)
    v_max3_f32 v47, v96, v97, v47
    v_max3_f32 v47, v98, v99, v47
    v_max3_f32 v47, v100, v101, v47
    v_max3_f32 v47, v102, v103, v47
    v_max3_f32 v47, v104, v105, v47
    v_mfma_f32_32x32x16_bf16 v[112:127], v[32:35], v[216:219], v[112:127]
    ds_read_b128 v[28:31], v4 offset:49152
    s_waitcnt lgkmcnt(4)
    v_max3_f32 v47, v106, v107, v47
    v_max3_f32 v47, v108, v109, v47
    v_max3_f32 v47, v110, v111, v47
    v_mul_f32 v42, s12, v47
    v_sub_f32 v62, v41, v42
    v_mfma_f32_32x32x16_bf16 v[112:127], v[36:39], v[220:223], v[112:127]
    ds_read_b128 v[32:35], v5 offset:49152
    s_waitcnt lgkmcnt(4)
    v_exp_f32 v62, v62
    s_nop 0
    v_mul_f32 v60, v60, v62
    v_fma_f32 v96, v96, s12, -v42
    v_fma_f32 v97, v97, s12, -v42
    s_barrier
    v_mfma_f32_32x32x16_bf16 v[112:127], v[16:19], v[224:227], v[112:127]
    ds_read_b128 v[36:39], v6 offset:49152
    s_waitcnt lgkmcnt(4)
    v_exp_f32 v96, v96
    v_fma_f32 v98, v98, s12, -v42
    v_exp_f32 v97, v97
    v_mfma_f32_32x32x16_bf16 v[112:127], v[20:23], v[228:231], v[112:127]
    ds_read_b128 v[16:19], v7 offset:49152
    s_waitcnt lgkmcnt(4)
    v_add_f32 v60, v60, v96
    v_fma_f32 v99, v99, s12, -v42
    v_exp_f32 v98, v98
    v_add_f32 v60, v60, v97
    v_mfma_f32_32x32x16_bf16 v[112:127], v[24:27], v[232:235], v[112:127]
    ds_read_b128 v[20:23], v8 offset:49152
    s_waitcnt lgkmcnt(4)
    v_fma_f32 v100, v100, s12, -v42
    v_exp_f32 v99, v99
    v_add_f32 v60, v60, v98
    v_fma_f32 v101, v101, s12, -v42
    v_mfma_f32_32x32x16_bf16 v[112:127], v[28:31], v[236:239], v[112:127]
    v_add_u32 v1, 0x10000, v1
    ds_read_b128 v[24:27], v1 offset:0
    s_waitcnt lgkmcnt(4)
    v_exp_f32 v100, v100
    v_add_f32 v60, v60, v99
    v_fma_f32 v102, v102, s12, -v42
    v_mfma_f32_32x32x16_bf16 v[112:127], v[32:35], v[240:243], v[112:127]
    v_add_u32 v2, 0x10000, v2
    ds_read_b128 v[28:31], v2 offset:0
    s_waitcnt lgkmcnt(4)
    v_exp_f32 v101, v101
    v_add_f32 v60, v60, v100
    v_fma_f32 v103, v103, s12, -v42
    v_mfma_f32_32x32x16_bf16 v[112:127], v[36:39], v[244:247], v[112:127]
    v_add_u32 v3, 0x10000, v3
    ds_read_b128 v[32:35], v3 offset:0
    s_waitcnt lgkmcnt(4)
    v_exp_f32 v102, v102
    v_add_f32 v60, v60, v101
    v_fma_f32 v104, v104, s12, -v42
    v_mfma_f32_32x32x16_bf16 v[112:127], v[16:19], v[248:251], v[112:127]
    v_add_u32 v4, 0x10000, v4
    ds_read_b128 v[36:39], v4 offset:0
    s_waitcnt lgkmcnt(4)
    v_exp_f32 v103, v103
    v_add_f32 v60, v60, v102
    v_fma_f32 v105, v105, s12, -v42
    v_exp_f32 v104, v104
    v_mfma_f32_32x32x16_bf16 v[112:127], v[20:23], v[252:255], v[112:127]
    v_add_u32 v5, 0x10000, v5
    ds_read_b128 v[16:19], v5 offset:0
    s_waitcnt lgkmcnt(4)
    v_add_f32 v60, v60, v103
    v_fma_f32 v106, v106, s12, -v42
    v_exp_f32 v105, v105
    v_add_f32 v60, v60, v104
    v_fma_f32 v107, v107, s12, -v42
    s_barrier
    v_mfma_f32_32x32x16_bf16 v[128:143], v[24:27], v[192:195], 0
    v_add_u32 v6, 0x10000, v6
    ds_read_b128 v[20:23], v6 offset:0
    s_waitcnt lgkmcnt(4)
    v_exp_f32 v106, v106
    v_add_f32 v60, v60, v105
    v_fma_f32 v108, v108, s12, -v42
    v_exp_f32 v107, v107
    v_mfma_f32_32x32x16_bf16 v[128:143], v[28:31], v[196:199], v[128:143]
    v_add_u32 v7, 0x10000, v7
    ds_read_b128 v[24:27], v7 offset:0
    s_waitcnt lgkmcnt(4)
    v_add_f32 v60, v60, v106
    v_fma_f32 v109, v109, s12, -v42
    v_exp_f32 v108, v108
    v_add_f32 v60, v60, v107
    v_fma_f32 v110, v110, s12, -v42
    v_mfma_f32_32x32x16_bf16 v[128:143], v[32:35], v[200:203], v[128:143]
    v_add_u32 v8, 0x10000, v8
    ds_read_b128 v[28:31], v8 offset:0
    s_waitcnt lgkmcnt(4)
    v_exp_f32 v109, v109
    v_add_f32 v60, v60, v108
    v_fma_f32 v111, v111, s12, -v42
    v_exp_f32 v110, v110
    v_mfma_f32_32x32x16_bf16 v[128:143], v[36:39], v[204:207], v[128:143]
    v_subrev_u32 v1, 0x20000, v1
    ds_read_b128 v[32:35], v1 offset:16384
    s_waitcnt lgkmcnt(4)
    v_add_f32 v60, v60, v109
    v_exp_f32 v111, v111
    v_add_f32 v60, v60, v110
    v_add_f32 v60, v60, v111
    v_max3_f32 v47, v112, v113, v47
    v_mfma_f32_32x32x16_bf16 v[128:143], v[16:19], v[208:211], v[128:143]
    v_subrev_u32 v2, 0x20000, v2
    ds_read_b128 v[36:39], v2 offset:16384
    s_waitcnt lgkmcnt(4)
    v_max3_f32 v47, v114, v115, v47
    v_max3_f32 v47, v116, v117, v47
    v_max3_f32 v47, v118, v119, v47
    v_max3_f32 v47, v120, v121, v47
    v_max3_f32 v47, v122, v123, v47
    v_max3_f32 v47, v124, v125, v47
    v_mfma_f32_32x32x16_bf16 v[128:143], v[20:23], v[212:215], v[128:143]
    v_subrev_u32 v3, 0x20000, v3
    ds_read_b128 v[16:19], v3 offset:16384
    s_waitcnt lgkmcnt(4)
    v_max3_f32 v47, v126, v127, v47
    v_mul_f32 v43, s12, v47
    v_sub_f32 v62, v42, v43
    v_exp_f32 v62, v62
    v_mfma_f32_32x32x16_bf16 v[128:143], v[24:27], v[216:219], v[128:143]
    v_subrev_u32 v4, 0x20000, v4
    ds_read_b128 v[20:23], v4 offset:16384
    s_waitcnt lgkmcnt(4)
    v_mul_f32 v60, v60, v62
    v_fma_f32 v112, v112, s12, -v43
    v_fma_f32 v113, v113, s12, -v43
    v_exp_f32 v112, v112
    v_mfma_f32_32x32x16_bf16 v[128:143], v[28:31], v[220:223], v[128:143]
    v_subrev_u32 v5, 0x20000, v5
    ds_read_b128 v[24:27], v5 offset:16384
    s_waitcnt lgkmcnt(4)
    v_fma_f32 v114, v114, s12, -v43
    v_exp_f32 v113, v113
    v_add_f32 v60, v60, v112
    v_fma_f32 v115, v115, s12, -v43
    s_barrier
    v_mfma_f32_32x32x16_bf16 v[128:143], v[32:35], v[224:227], v[128:143]
    v_subrev_u32 v6, 0x20000, v6
    ds_read_b128 v[28:31], v6 offset:16384
    s_waitcnt lgkmcnt(4)
    v_exp_f32 v114, v114
    v_add_f32 v60, v60, v113
    v_fma_f32 v116, v116, s12, -v43
    v_mfma_f32_32x32x16_bf16 v[128:143], v[36:39], v[228:231], v[128:143]
    v_subrev_u32 v7, 0x20000, v7
    ds_read_b128 v[32:35], v7 offset:16384
    s_waitcnt lgkmcnt(4)
    v_exp_f32 v115, v115
    v_add_f32 v60, v60, v114
    v_fma_f32 v117, v117, s12, -v43
    v_exp_f32 v116, v116
    v_mfma_f32_32x32x16_bf16 v[128:143], v[16:19], v[232:235], v[128:143]
    v_subrev_u32 v8, 0x20000, v8
    ds_read_b128 v[36:39], v8 offset:16384
    s_waitcnt lgkmcnt(4)
    v_add_f32 v60, v60, v115
    v_fma_f32 v118, v118, s12, -v43
    v_exp_f32 v117, v117
    v_add_f32 v60, v60, v116
    v_mfma_f32_32x32x16_bf16 v[128:143], v[20:23], v[236:239], v[128:143]
    ds_read_b128 v[16:19], v1 offset:32768
    s_waitcnt lgkmcnt(4)
    v_fma_f32 v119, v119, s12, -v43
    v_exp_f32 v118, v118
    v_add_f32 v60, v60, v117
    v_fma_f32 v120, v120, s12, -v43
    v_mfma_f32_32x32x16_bf16 v[128:143], v[24:27], v[240:243], v[128:143]
    ds_read_b128 v[20:23], v2 offset:32768
    s_waitcnt lgkmcnt(4)
    v_exp_f32 v119, v119
    v_add_f32 v60, v60, v118
    v_fma_f32 v121, v121, s12, -v43
    v_mfma_f32_32x32x16_bf16 v[128:143], v[28:31], v[244:247], v[128:143]
    ds_read_b128 v[24:27], v3 offset:32768
    s_waitcnt lgkmcnt(4)
    v_exp_f32 v120, v120
    v_add_f32 v60, v60, v119
    v_fma_f32 v122, v122, s12, -v43
    v_exp_f32 v121, v121
    v_mfma_f32_32x32x16_bf16 v[128:143], v[32:35], v[248:251], v[128:143]
    ds_read_b128 v[28:31], v4 offset:32768
    s_waitcnt lgkmcnt(4)
    v_add_f32 v60, v60, v120
    v_fma_f32 v123, v123, s12, -v43
    v_exp_f32 v122, v122
    v_add_f32 v60, v60, v121
    v_mfma_f32_32x32x16_bf16 v[128:143], v[36:39], v[252:255], v[128:143]
    ds_read_b128 v[32:35], v5 offset:32768
    s_waitcnt lgkmcnt(4)
    v_fma_f32 v124, v124, s12, -v43
    v_exp_f32 v123, v123
    v_add_f32 v60, v60, v122
    v_fma_f32 v125, v125, s12, -v43
    s_barrier
    v_mfma_f32_32x32x16_bf16 v[144:159], v[16:19], v[192:195], 0
    ds_read_b128 v[36:39], v6 offset:32768
    s_waitcnt lgkmcnt(4)
    v_exp_f32 v124, v124
    v_add_f32 v60, v60, v123
    v_fma_f32 v126, v126, s12, -v43
    v_mfma_f32_32x32x16_bf16 v[144:159], v[20:23], v[196:199], v[144:159]
    ds_read_b128 v[16:19], v7 offset:32768
    s_waitcnt lgkmcnt(4)
    v_exp_f32 v125, v125
    v_add_f32 v60, v60, v124
    v_fma_f32 v127, v127, s12, -v43
    v_exp_f32 v126, v126
    v_mfma_f32_32x32x16_bf16 v[144:159], v[24:27], v[200:203], v[144:159]
    ds_read_b128 v[20:23], v8 offset:32768
    s_waitcnt lgkmcnt(4)
    v_add_f32 v60, v60, v125
    v_exp_f32 v127, v127
    v_add_f32 v60, v60, v126
    v_add_f32 v60, v60, v127
    v_mfma_f32_32x32x16_bf16 v[144:159], v[28:31], v[204:207], v[144:159]
    v_add_u32 v1, 0x20000, v1
    ds_read_b128 v[24:27], v1 offset:16384
    s_waitcnt lgkmcnt(4)
    v_max3_f32 v47, v128, v129, v47
    v_max3_f32 v47, v130, v131, v47
    v_max3_f32 v47, v132, v133, v47
    v_max3_f32 v47, v134, v135, v47
    v_max3_f32 v47, v136, v137, v47
    v_mfma_f32_32x32x16_bf16 v[144:159], v[32:35], v[208:211], v[144:159]
    v_add_u32 v2, 0x20000, v2
    ds_read_b128 v[28:31], v2 offset:16384
    s_waitcnt lgkmcnt(4)
    v_max3_f32 v47, v138, v139, v47
    v_max3_f32 v47, v140, v141, v47
    v_max3_f32 v47, v142, v143, v47
    v_mul_f32 v44, s12, v47
    v_sub_f32 v62, v43, v44
    v_mfma_f32_32x32x16_bf16 v[144:159], v[36:39], v[212:215], v[144:159]
    v_add_u32 v3, 0x20000, v3
    ds_read_b128 v[32:35], v3 offset:16384
    s_waitcnt lgkmcnt(4)
    v_exp_f32 v62, v62
    s_nop 0
    v_mul_f32 v60, v60, v62
    v_fma_f32 v128, v128, s12, -v44
    v_fma_f32 v129, v129, s12, -v44
    v_mfma_f32_32x32x16_bf16 v[144:159], v[16:19], v[216:219], v[144:159]
    v_add_u32 v4, 0x20000, v4
    ds_read_b128 v[36:39], v4 offset:16384
    s_waitcnt lgkmcnt(4)
    v_exp_f32 v128, v128
    v_fma_f32 v130, v130, s12, -v44
    v_exp_f32 v129, v129
    v_mfma_f32_32x32x16_bf16 v[144:159], v[20:23], v[220:223], v[144:159]
    v_add_u32 v5, 0x20000, v5
    ds_read_b128 v[16:19], v5 offset:16384
    s_waitcnt lgkmcnt(4)
    v_add_f32 v60, v60, v128
    v_fma_f32 v131, v131, s12, -v44
    v_exp_f32 v130, v130
    v_add_f32 v60, v60, v129
    s_barrier
    v_mfma_f32_32x32x16_bf16 v[144:159], v[24:27], v[224:227], v[144:159]
    v_add_u32 v6, 0x20000, v6
    ds_read_b128 v[20:23], v6 offset:16384
    s_waitcnt lgkmcnt(4)
    v_fma_f32 v132, v132, s12, -v44
    v_exp_f32 v131, v131
    v_add_f32 v60, v60, v130
    v_fma_f32 v133, v133, s12, -v44
    v_mfma_f32_32x32x16_bf16 v[144:159], v[28:31], v[228:231], v[144:159]
    v_add_u32 v7, 0x20000, v7
    ds_read_b128 v[24:27], v7 offset:16384
    s_waitcnt lgkmcnt(4)
    v_exp_f32 v132, v132
    v_add_f32 v60, v60, v131
    v_fma_f32 v134, v134, s12, -v44
    v_mfma_f32_32x32x16_bf16 v[144:159], v[32:35], v[232:235], v[144:159]
    v_add_u32 v8, 0x20000, v8
    ds_read_b128 v[28:31], v8 offset:16384
    s_waitcnt lgkmcnt(4)
    v_exp_f32 v133, v133
    v_add_f32 v60, v60, v132
    v_fma_f32 v135, v135, s12, -v44
    v_exp_f32 v134, v134
    v_mfma_f32_32x32x16_bf16 v[144:159], v[36:39], v[236:239], v[144:159]
    v_subrev_u32 v1, 0x20000, v1
    ds_read_b128 v[32:35], v1 offset:0
    s_waitcnt lgkmcnt(4)
    v_add_f32 v60, v60, v133
    v_fma_f32 v136, v136, s12, -v44
    v_exp_f32 v135, v135
    v_add_f32 v60, v60, v134
    v_mfma_f32_32x32x16_bf16 v[144:159], v[16:19], v[240:243], v[144:159]
    v_subrev_u32 v2, 0x20000, v2
    ds_read_b128 v[36:39], v2 offset:0
    s_waitcnt lgkmcnt(4)
    v_fma_f32 v137, v137, s12, -v44
    v_exp_f32 v136, v136
    v_add_f32 v60, v60, v135
    v_fma_f32 v138, v138, s12, -v44
    v_mfma_f32_32x32x16_bf16 v[144:159], v[20:23], v[244:247], v[144:159]
    v_subrev_u32 v3, 0x20000, v3
    ds_read_b128 v[16:19], v3 offset:0
    s_waitcnt lgkmcnt(4)
    v_exp_f32 v137, v137
    v_add_f32 v60, v60, v136
    v_fma_f32 v139, v139, s12, -v44
    v_mfma_f32_32x32x16_bf16 v[144:159], v[24:27], v[248:251], v[144:159]
    v_subrev_u32 v4, 0x20000, v4
    ds_read_b128 v[20:23], v4 offset:0
    s_waitcnt lgkmcnt(4)
    v_exp_f32 v138, v138
    v_add_f32 v60, v60, v137
    v_fma_f32 v140, v140, s12, -v44
    v_exp_f32 v139, v139
    v_mfma_f32_32x32x16_bf16 v[144:159], v[28:31], v[252:255], v[144:159]
    v_subrev_u32 v5, 0x20000, v5
    ds_read_b128 v[24:27], v5 offset:0
    s_waitcnt lgkmcnt(4)
    v_add_f32 v60, v60, v138
    v_fma_f32 v141, v141, s12, -v44
    v_exp_f32 v140, v140
    v_add_f32 v60, v60, v139
    s_barrier
    v_mfma_f32_32x32x16_bf16 v[160:175], v[32:35], v[192:195], 0
    v_subrev_u32 v6, 0x20000, v6
    ds_read_b128 v[28:31], v6 offset:0
    s_waitcnt lgkmcnt(4)
    v_fma_f32 v142, v142, s12, -v44
    v_exp_f32 v141, v141
    v_add_f32 v60, v60, v140
    v_fma_f32 v143, v143, s12, -v44
    v_mfma_f32_32x32x16_bf16 v[160:175], v[36:39], v[196:199], v[160:175]
    v_subrev_u32 v7, 0x20000, v7
    ds_read_b128 v[32:35], v7 offset:0
    s_waitcnt lgkmcnt(4)
    v_exp_f32 v142, v142
    v_add_f32 v60, v60, v141
    v_exp_f32 v143, v143
    v_mfma_f32_32x32x16_bf16 v[160:175], v[16:19], v[200:203], v[160:175]
    v_subrev_u32 v8, 0x20000, v8
    ds_read_b128 v[36:39], v8 offset:0
    s_waitcnt lgkmcnt(4)
    v_add_f32 v60, v60, v142
    v_add_f32 v60, v60, v143
    v_max3_f32 v47, v144, v145, v47
    v_max3_f32 v47, v146, v147, v47
    v_max3_f32 v47, v148, v149, v47
    v_mfma_f32_32x32x16_bf16 v[160:175], v[20:23], v[204:207], v[160:175]
    ds_read_b128 v[16:19], v1 offset:49152
    s_waitcnt lgkmcnt(4)
    v_max3_f32 v47, v150, v151, v47
    v_max3_f32 v47, v152, v153, v47
    v_max3_f32 v47, v154, v155, v47
    v_max3_f32 v47, v156, v157, v47
    v_max3_f32 v47, v158, v159, v47
    v_mfma_f32_32x32x16_bf16 v[160:175], v[24:27], v[208:211], v[160:175]
    ds_read_b128 v[20:23], v2 offset:49152
    s_waitcnt lgkmcnt(4)
    v_mul_f32 v45, s12, v47
    v_sub_f32 v62, v44, v45
    v_exp_f32 v62, v62
    s_nop 0
    v_mul_f32 v60, v60, v62
    v_mfma_f32_32x32x16_bf16 v[160:175], v[28:31], v[212:215], v[160:175]
    ds_read_b128 v[24:27], v3 offset:49152
    s_waitcnt lgkmcnt(4)
    s_lshl_b32 s10, s3, 7
    s_add_u32 s10, s10, 114688
    v_and_b32 v13, 31, v0
    v_lshl_add_u32 v13, v13, 2, s10
    v_mov_b32 v15, v47
    v_mfma_f32_32x32x16_bf16 v[160:175], v[32:35], v[216:219], v[160:175]
    ds_read_b128 v[28:31], v4 offset:49152
    s_waitcnt lgkmcnt(4)
    v_mov_b32 v63, v47
    s_nop 0
    s_nop 0
    v_permlane32_swap_b32 v15, v63
    v_max_f32 v63, v63, v15
    ds_write_b32 v13, v63 offset:0
    v_mfma_f32_32x32x16_bf16 v[160:175], v[36:39], v[220:223], v[160:175]
    ds_read_b128 v[32:35], v5 offset:49152
    s_waitcnt lgkmcnt(5)
    s_waitcnt lgkmcnt(1)
    s_barrier
    v_mfma_f32_32x32x16_bf16 v[160:175], v[16:19], v[224:227], v[160:175]
    ds_read_b128 v[36:39], v6 offset:49152
    v_xor_b32 v15, 128, v13
    ds_read_b32 v61, v15 offset:0
    v_fma_f32 v144, v144, s12, -v45
    v_fma_f32 v145, v145, s12, -v45
    v_mfma_f32_32x32x16_bf16 v[160:175], v[20:23], v[228:231], v[160:175]
    ds_read_b128 v[16:19], v7 offset:49152
    v_exp_f32 v144, v144
    v_fma_f32 v146, v146, s12, -v45
    v_exp_f32 v145, v145
    v_mfma_f32_32x32x16_bf16 v[160:175], v[24:27], v[232:235], v[160:175]
    ds_read_b128 v[20:23], v8 offset:49152
    v_add_f32 v60, v60, v144
    v_fma_f32 v147, v147, s12, -v45
    v_exp_f32 v146, v146
    v_add_f32 v60, v60, v145
    v_mfma_f32_32x32x16_bf16 v[160:175], v[28:31], v[236:239], v[160:175]
    v_add_u32 v1, 0x10000, v1
    ds_read_b128 v[24:27], v1 offset:0
    s_waitcnt lgkmcnt(5)
    s_waitcnt lgkmcnt(3)
    v_max_f32 v61, v61, v63
    v_mul_f32 v61, s12, v61
    v_sub_f32 v62, v40, v61
    v_exp_f32 v62, v62
    v_mfma_f32_32x32x16_bf16 v[160:175], v[32:35], v[240:243], v[160:175]
    v_add_u32 v2, 0x10000, v2
    ds_read_b128 v[28:31], v2 offset:0
    v_mul_f32 v64, v62, v64
    v_mul_f32 v65, v62, v65
    v_mul_f32 v66, v62, v66
    v_mul_f32 v67, v62, v67
    v_mul_f32 v68, v62, v68
    v_mfma_f32_32x32x16_bf16 v[160:175], v[36:39], v[244:247], v[160:175]
    v_add_u32 v3, 0x10000, v3
    ds_read_b128 v[32:35], v3 offset:0
    s_waitcnt lgkmcnt(4)
    v_mul_f32 v69, v62, v69
    v_mul_f32 v70, v62, v70
    v_mul_f32 v71, v62, v71
    v_cvt_pk_bf16_f32 v64, v64, v65
    v_cvt_pk_bf16_f32 v65, v66, v67
    v_cvt_pk_bf16_f32 v66, v68, v69
    v_mfma_f32_32x32x16_bf16 v[160:175], v[16:19], v[248:251], v[160:175]
    v_add_u32 v4, 0x10000, v4
    ds_read_b128 v[36:39], v4 offset:0
    s_waitcnt lgkmcnt(4)
    v_cvt_pk_bf16_f32 v67, v70, v71
    ds_write_b128 v14, v[64:67] offset:16384
    v_mul_f32 v72, v62, v72
    v_mul_f32 v73, v62, v73
    v_mul_f32 v74, v62, v74
    v_mul_f32 v75, v62, v75
    v_mfma_f32_32x32x16_bf16 v[160:175], v[20:23], v[252:255], v[160:175]
    v_add_u32 v5, 0x10000, v5
    ds_read_b128 v[16:19], v5 offset:0
    s_waitcnt lgkmcnt(5)
    v_mul_f32 v76, v62, v76
    v_mul_f32 v77, v62, v77
    v_mul_f32 v78, v62, v78
    v_mul_f32 v79, v62, v79
    v_cvt_pk_bf16_f32 v72, v72, v73
    v_cvt_pk_bf16_f32 v73, v74, v75
    s_barrier
    v_mfma_f32_32x32x16_bf16 v[176:191], v[24:27], v[192:195], 0
    v_add_u32 v6, 0x10000, v6
    ds_read_b128 v[20:23], v6 offset:0
    s_waitcnt lgkmcnt(5)
    v_cvt_pk_bf16_f32 v74, v76, v77
    v_cvt_pk_bf16_f32 v75, v78, v79
    ds_write_b128 v14, v[72:75] offset:17408
    v_fma_f32 v148, v148, s12, -v45
    v_exp_f32 v147, v147
    v_mfma_f32_32x32x16_bf16 v[176:191], v[28:31], v[196:199], v[176:191]
    v_add_u32 v7, 0x10000, v7
    ds_read_b128 v[24:27], v7 offset:0
    s_waitcnt lgkmcnt(6)
    v_add_f32 v60, v60, v146
    v_fma_f32 v149, v149, s12, -v45
    v_exp_f32 v148, v148
    v_add_f32 v60, v60, v147
    v_fma_f32 v150, v150, s12, -v45
    v_mfma_f32_32x32x16_bf16 v[176:191], v[32:35], v[200:203], v[176:191]
    v_add_u32 v8, 0x10000, v8
    ds_read_b128 v[28:31], v8 offset:0
    s_waitcnt lgkmcnt(6)
    v_exp_f32 v149, v149
    v_add_f32 v60, v60, v148
    v_fma_f32 v151, v151, s12, -v45
    v_exp_f32 v150, v150
    v_mfma_f32_32x32x16_bf16 v[176:191], v[36:39], v[204:207], v[176:191]
    ds_read_b128 v[32:35], v1 offset:16384
    s_waitcnt lgkmcnt(5)
    v_add_f32 v60, v60, v149
    v_fma_f32 v152, v152, s12, -v45
    v_exp_f32 v151, v151
    v_add_f32 v60, v60, v150
    v_fma_f32 v153, v153, s12, -v45
    v_mfma_f32_32x32x16_bf16 v[176:191], v[16:19], v[208:211], v[176:191]
    ds_read_b128 v[36:39], v2 offset:16384
    s_waitcnt lgkmcnt(5)
    v_exp_f32 v152, v152
    v_add_f32 v60, v60, v151
    v_fma_f32 v154, v154, s12, -v45
    v_exp_f32 v153, v153
    v_mfma_f32_32x32x16_bf16 v[176:191], v[20:23], v[212:215], v[176:191]
    ds_read_b128 v[16:19], v3 offset:16384
    s_waitcnt lgkmcnt(4)
    v_add_f32 v60, v60, v152
    v_fma_f32 v155, v155, s12, -v45
    v_exp_f32 v154, v154
    v_add_f32 v60, v60, v153
    v_fma_f32 v156, v156, s12, -v45
    v_mfma_f32_32x32x16_bf16 v[176:191], v[24:27], v[216:219], v[176:191]
    ds_read_b128 v[20:23], v4 offset:16384
    s_waitcnt lgkmcnt(4)
    v_exp_f32 v155, v155
    v_add_f32 v60, v60, v154
    v_fma_f32 v157, v157, s12, -v45
    v_exp_f32 v156, v156
    v_mfma_f32_32x32x16_bf16 v[176:191], v[28:31], v[220:223], v[176:191]
    ds_read_b128 v[24:27], v5 offset:16384
    s_waitcnt lgkmcnt(4)
    v_add_f32 v60, v60, v155
    v_fma_f32 v158, v158, s12, -v45
    v_exp_f32 v157, v157
    v_add_f32 v60, v60, v156
    v_fma_f32 v159, v159, s12, -v45
    s_barrier
    v_mfma_f32_32x32x16_bf16 v[176:191], v[32:35], v[224:227], v[176:191]
    ds_read_b128 v[28:31], v6 offset:16384
    s_waitcnt lgkmcnt(4)
    v_exp_f32 v158, v158
    v_add_f32 v60, v60, v157
    v_exp_f32 v159, v159
    v_add_f32 v60, v60, v158
    v_mfma_f32_32x32x16_bf16 v[176:191], v[36:39], v[228:231], v[176:191]
    ds_read_b128 v[32:35], v7 offset:16384
    s_waitcnt lgkmcnt(4)
    v_add_f32 v60, v60, v159
    v_max3_f32 v47, v160, v161, v47
    v_max3_f32 v47, v162, v163, v47
    v_max3_f32 v47, v164, v165, v47
    v_max3_f32 v47, v166, v167, v47
    v_mfma_f32_32x32x16_bf16 v[176:191], v[16:19], v[232:235], v[176:191]
    ds_read_b128 v[36:39], v8 offset:16384
    s_waitcnt lgkmcnt(4)
    v_max3_f32 v47, v168, v169, v47
    v_max3_f32 v47, v170, v171, v47
    v_max3_f32 v47, v172, v173, v47
    v_max3_f32 v47, v174, v175, v47
    v_mul_f32 v46, s12, v47
    v_mfma_f32_32x32x16_bf16 v[176:191], v[20:23], v[236:239], v[176:191]
    v_add_u32 v9, 0x10000, v9
    ds_read_b64_tr_b16 v[16:17], v9 offset:32768
    ds_read_b64_tr_b16 v[18:19], v9 offset:34816
    s_waitcnt lgkmcnt(5)
    v_sub_f32 v62, v45, v46
    v_exp_f32 v62, v62
    s_nop 0
    v_mul_f32 v60, v60, v62
    v_sub_f32 v62, v41, v61
    v_mfma_f32_32x32x16_bf16 v[176:191], v[24:27], v[240:243], v[176:191]
    v_add_u32 v10, 0x10000, v10
    ds_read_b64_tr_b16 v[20:21], v10 offset:32768
    ds_read_b64_tr_b16 v[22:23], v10 offset:34816
    ds_read_b128 v[48:51], v12 offset:16384
    s_waitcnt lgkmcnt(7)
    v_exp_f32 v62, v62
    s_nop 0
    v_mul_f32 v80, v62, v80
    v_mul_f32 v81, v62, v81
    v_mul_f32 v82, v62, v82
    v_mfma_f32_32x32x16_bf16 v[176:191], v[28:31], v[244:247], v[176:191]
    ds_read_b64_tr_b16 v[24:25], v9 offset:36864
    ds_read_b64_tr_b16 v[26:27], v9 offset:38912
    s_waitcnt lgkmcnt(8)
    v_mul_f32 v83, v62, v83
    v_mul_f32 v84, v62, v84
    v_mul_f32 v85, v62, v85
    v_mul_f32 v86, v62, v86
    v_mul_f32 v87, v62, v87
    v_cvt_pk_bf16_f32 v80, v80, v81
    v_mfma_f32_32x32x16_bf16 v[176:191], v[32:35], v[248:251], v[176:191]
    ds_read_b64_tr_b16 v[28:29], v10 offset:36864
    ds_read_b64_tr_b16 v[30:31], v10 offset:38912
    ds_read_b128 v[52:55], v12 offset:17408
    s_waitcnt lgkmcnt(10)
    v_cvt_pk_bf16_f32 v81, v82, v83
    v_cvt_pk_bf16_f32 v82, v84, v85
    v_cvt_pk_bf16_f32 v83, v86, v87
    ds_write_b128 v14, v[80:83] offset:24576
    v_mul_f32 v88, v62, v88
    v_mul_f32 v89, v62, v89
    v_mfma_f32_32x32x16_bf16 v[176:191], v[36:39], v[252:255], v[176:191]
    ds_read_b64_tr_b16 v[32:33], v9 offset:40960
    ds_read_b64_tr_b16 v[34:35], v9 offset:43008
    s_waitcnt lgkmcnt(8)
    v_mul_f32 v90, v62, v90
    v_mul_f32 v91, v62, v91
    v_mul_f32 v92, v62, v92
    v_mul_f32 v93, v62, v93
    v_mul_f32 v94, v62, v94
    v_mul_f32 v95, v62, v95
    s_barrier
    v_mfma_f32_32x32x16_bf16 v[192:207], v[16:19], v[48:51], 0
    ds_read_b64_tr_b16 v[36:37], v10 offset:40960
    ds_read_b64_tr_b16 v[38:39], v10 offset:43008
    ds_read_b128 v[56:59], v12 offset:20480
    v_cvt_pk_bf16_f32 v88, v88, v89
    v_cvt_pk_bf16_f32 v89, v90, v91
    v_cvt_pk_bf16_f32 v90, v92, v93
    v_cvt_pk_bf16_f32 v91, v94, v95
    v_mfma_f32_32x32x16_bf16 v[208:223], v[20:23], v[48:51], 0
    ds_read_b64_tr_b16 v[16:17], v9 offset:45056
    ds_read_b64_tr_b16 v[18:19], v9 offset:47104
    s_waitcnt lgkmcnt(8)
    ds_write_b128 v14, v[88:91] offset:25600
    v_mfma_f32_32x32x16_bf16 v[192:207], v[24:27], v[52:55], v[192:207]
    ds_read_b64_tr_b16 v[20:21], v10 offset:45056
    ds_read_b64_tr_b16 v[22:23], v10 offset:47104
    ds_read_b128 v[48:51], v12 offset:21504
    v_max3_f32 v47, v176, v177, v47
    v_max3_f32 v47, v178, v179, v47
    v_max3_f32 v47, v180, v181, v47
    v_max3_f32 v47, v182, v183, v47
    v_mfma_f32_32x32x16_bf16 v[208:223], v[28:31], v[52:55], v[208:223]
    v_add_u32 v9, 0x10000, v9
    ds_read_b64_tr_b16 v[24:25], v9 offset:0
    ds_read_b64_tr_b16 v[26:27], v9 offset:2048
    s_waitcnt lgkmcnt(8)
    v_max3_f32 v47, v184, v185, v47
    v_max3_f32 v47, v186, v187, v47
    v_max3_f32 v47, v188, v189, v47
    v_max3_f32 v47, v190, v191, v47
    v_mov_b32 v15, v47
    v_mfma_f32_32x32x16_bf16 v[192:207], v[32:35], v[56:59], v[192:207]
    v_add_u32 v10, 0x10000, v10
    ds_read_b64_tr_b16 v[28:29], v10 offset:0
    ds_read_b64_tr_b16 v[30:31], v10 offset:2048
    ds_read_b128 v[52:55], v12 offset:16384
    v_mov_b32 v63, v47
    s_nop 0
    s_nop 0
    v_permlane32_swap_b32 v15, v63
    v_max_f32 v63, v63, v15
    v_mfma_f32_32x32x16_bf16 v[208:223], v[36:39], v[56:59], v[208:223]
    ds_read_b64_tr_b16 v[32:33], v9 offset:4096
    ds_read_b64_tr_b16 v[34:35], v9 offset:6144
    s_waitcnt lgkmcnt(7)
    ds_write_b32 v13, v63 offset:512
    v_fma_f32 v160, v160, s12, -v46
    v_fma_f32 v161, v161, s12, -v46
    v_exp_f32 v160, v160
    v_mfma_f32_32x32x16_bf16 v[192:207], v[16:19], v[48:51], v[192:207]
    ds_read_b64_tr_b16 v[36:37], v10 offset:4096
    ds_read_b64_tr_b16 v[38:39], v10 offset:6144
    ds_read_b128 v[56:59], v12 offset:17408
    v_fma_f32 v162, v162, s12, -v46
    v_exp_f32 v161, v161
    v_add_f32 v60, v60, v160
    v_mfma_f32_32x32x16_bf16 v[208:223], v[20:23], v[48:51], v[208:223]
    ds_read_b64_tr_b16 v[16:17], v9 offset:8192
    ds_read_b64_tr_b16 v[18:19], v9 offset:10240
    s_waitcnt lgkmcnt(8)
    v_fma_f32 v163, v163, s12, -v46
    v_exp_f32 v162, v162
    v_add_f32 v60, v60, v161
    v_fma_f32 v164, v164, s12, -v46
    s_barrier
    v_mfma_f32_32x32x16_bf16 v[224:239], v[24:27], v[52:55], 0
    ds_read_b64_tr_b16 v[20:21], v10 offset:8192
    ds_read_b64_tr_b16 v[22:23], v10 offset:10240
    ds_read_b128 v[48:51], v12 offset:20480
    v_exp_f32 v163, v163
    v_add_f32 v60, v60, v162
    v_fma_f32 v165, v165, s12, -v46
    v_mfma_f32_32x32x16_bf16 v[240:255], v[28:31], v[52:55], 0
    ds_read_b64_tr_b16 v[24:25], v9 offset:12288
    ds_read_b64_tr_b16 v[26:27], v9 offset:14336
    s_waitcnt lgkmcnt(7)
    v_exp_f32 v164, v164
    v_add_f32 v60, v60, v163
    v_fma_f32 v166, v166, s12, -v46
    v_mfma_f32_32x32x16_bf16 v[224:239], v[32:35], v[56:59], v[224:239]
    ds_read_b64_tr_b16 v[28:29], v10 offset:12288
    ds_read_b64_tr_b16 v[30:31], v10 offset:14336
    ds_read_b128 v[52:55], v12 offset:21504
    v_exp_f32 v165, v165
    v_add_f32 v60, v60, v164
    v_mfma_f32_32x32x16_bf16 v[240:255], v[36:39], v[56:59], v[240:255]
    v_subrev_u32 v9, 0x20000, v9
    ds_read_b64_tr_b16 v[32:33], v9 offset:32768
    ds_read_b64_tr_b16 v[34:35], v9 offset:34816
    s_waitcnt lgkmcnt(7)
    v_mfma_f32_32x32x16_bf16 v[224:239], v[16:19], v[48:51], v[224:239]
    v_subrev_u32 v10, 0x20000, v10
    ds_read_b64_tr_b16 v[36:37], v10 offset:32768
    ds_read_b64_tr_b16 v[38:39], v10 offset:34816
    ds_read_b128 v[56:59], v12 offset:24576
    v_mfma_f32_32x32x16_bf16 v[240:255], v[20:23], v[48:51], v[240:255]
    ds_read_b64_tr_b16 v[16:17], v9 offset:36864
    ds_read_b64_tr_b16 v[18:19], v9 offset:38912
    s_waitcnt lgkmcnt(7)
    v_mfma_f32_32x32x16_bf16 v[224:239], v[24:27], v[52:55], v[224:239]
    ds_read_b64_tr_b16 v[20:21], v10 offset:36864
    ds_read_b64_tr_b16 v[22:23], v10 offset:38912
    ds_read_b128 v[48:51], v12 offset:25600
    v_mfma_f32_32x32x16_bf16 v[240:255], v[28:31], v[52:55], v[240:255]
    ds_read_b64_tr_b16 v[24:25], v9 offset:40960
    ds_read_b64_tr_b16 v[26:27], v9 offset:43008
    s_waitcnt lgkmcnt(7)
    s_barrier
    v_mfma_f32_32x32x16_bf16 v[192:207], v[32:35], v[56:59], v[192:207]
    ds_read_b64_tr_b16 v[28:29], v10 offset:40960
    ds_read_b64_tr_b16 v[30:31], v10 offset:43008
    ds_read_b128 v[52:55], v12 offset:28672
    v_xor_b32 v15, 128, v13
    ds_read_b32 v40, v15 offset:512
    v_sub_f32 v62, v42, v61
    v_exp_f32 v62, v62
    v_mfma_f32_32x32x16_bf16 v[208:223], v[36:39], v[56:59], v[208:223]
    ds_read_b64_tr_b16 v[32:33], v9 offset:45056
    ds_read_b64_tr_b16 v[34:35], v9 offset:47104
    s_waitcnt lgkmcnt(8)
    v_mul_f32 v96, v62, v96
    v_mul_f32 v97, v62, v97
    v_mul_f32 v98, v62, v98
    v_mul_f32 v99, v62, v99
    v_mul_f32 v100, v62, v100
    v_mul_f32 v101, v62, v101
    v_mfma_f32_32x32x16_bf16 v[192:207], v[16:19], v[48:51], v[192:207]
    ds_read_b64_tr_b16 v[36:37], v10 offset:45056
    ds_read_b64_tr_b16 v[38:39], v10 offset:47104
    ds_read_b128 v[56:59], v12 offset:29696
    v_mul_f32 v102, v62, v102
    v_mul_f32 v103, v62, v103
    v_cvt_pk_bf16_f32 v96, v96, v97
    v_cvt_pk_bf16_f32 v97, v98, v99
    v_cvt_pk_bf16_f32 v98, v100, v101
    v_mfma_f32_32x32x16_bf16 v[208:223], v[20:23], v[48:51], v[208:223]
    v_add_u32 v9, 0x20000, v9
    ds_read_b64_tr_b16 v[16:17], v9 offset:16384
    ds_read_b64_tr_b16 v[18:19], v9 offset:18432
    s_waitcnt lgkmcnt(8)
    v_cvt_pk_bf16_f32 v99, v102, v103
    v_add_u32 v14, 0x10000, v14
    ds_write_b128 v14, v[96:99] offset:0
    v_mul_f32 v104, v62, v104
    v_mul_f32 v105, v62, v105
    v_mul_f32 v106, v62, v106
    v_mul_f32 v107, v62, v107
    v_mfma_f32_32x32x16_bf16 v[192:207], v[24:27], v[52:55], v[192:207]
    v_add_u32 v10, 0x20000, v10
    ds_read_b64_tr_b16 v[20:21], v10 offset:16384
    ds_read_b64_tr_b16 v[22:23], v10 offset:18432
    ds_read_b128 v[48:51], v12 offset:24576
    v_mul_f32 v108, v62, v108
    v_mul_f32 v109, v62, v109
    v_mul_f32 v110, v62, v110
    v_mul_f32 v111, v62, v111
    v_cvt_pk_bf16_f32 v104, v104, v105
    v_mfma_f32_32x32x16_bf16 v[208:223], v[28:31], v[52:55], v[208:223]
    ds_read_b64_tr_b16 v[24:25], v9 offset:20480
    ds_read_b64_tr_b16 v[26:27], v9 offset:22528
    s_waitcnt lgkmcnt(8)
    v_cvt_pk_bf16_f32 v105, v106, v107
    v_cvt_pk_bf16_f32 v106, v108, v109
    v_cvt_pk_bf16_f32 v107, v110, v111
    ds_write_b128 v14, v[104:107] offset:1024
    s_mul_i32 s10, s5, 14336
    s_mul_i32 s11, s3, 3584
    v_mfma_f32_32x32x16_bf16 v[192:207], v[32:35], v[56:59], v[192:207]
    ds_read_b64_tr_b16 v[28:29], v10 offset:20480
    ds_read_b64_tr_b16 v[30:31], v10 offset:22528
    ds_read_b128 v[52:55], v12 offset:25600
    s_add_u32 s10, s10, s11
    v_and_b32 v15, 31, v0
    v_lshlrev_b32 v15, 7, v15
    buffer_load_dword v69, v15, s[92:95], s10 offen
    v_fma_f32 v167, v167, s12, -v46
    v_mfma_f32_32x32x16_bf16 v[208:223], v[36:39], v[56:59], v[208:223]
    ds_read_b64_tr_b16 v[32:33], v9 offset:24576
    ds_read_b64_tr_b16 v[34:35], v9 offset:26624
    s_waitcnt lgkmcnt(8)
    v_exp_f32 v166, v166
    v_add_f32 v60, v60, v165
    v_fma_f32 v168, v168, s12, -v46
    v_exp_f32 v167, v167
    s_waitcnt lgkmcnt(5)
    s_barrier
    v_mfma_f32_32x32x16_bf16 v[224:239], v[16:19], v[48:51], v[224:239]
    ds_read_b64_tr_b16 v[36:37], v10 offset:24576
    ds_read_b64_tr_b16 v[38:39], v10 offset:26624
    ds_read_b128 v[56:59], v12 offset:28672
    v_add_f32 v60, v60, v166
    v_fma_f32 v169, v169, s12, -v46
    v_exp_f32 v168, v168
    v_add_f32 v60, v60, v167
    v_mfma_f32_32x32x16_bf16 v[240:255], v[20:23], v[48:51], v[240:255]
    ds_read_b64_tr_b16 v[16:17], v9 offset:28672
    ds_read_b64_tr_b16 v[18:19], v9 offset:30720
    s_waitcnt lgkmcnt(7)
    v_fma_f32 v170, v170, s12, -v46
    v_exp_f32 v169, v169
    v_add_f32 v60, v60, v168
    v_fma_f32 v171, v171, s12, -v46
    v_mfma_f32_32x32x16_bf16 v[224:239], v[24:27], v[52:55], v[224:239]
    ds_read_b64_tr_b16 v[20:21], v10 offset:28672
    ds_read_b64_tr_b16 v[22:23], v10 offset:30720
    ds_read_b128 v[48:51], v12 offset:29696
    v_exp_f32 v170, v170
    v_add_f32 v60, v60, v169
    v_fma_f32 v172, v172, s12, -v46
    v_mfma_f32_32x32x16_bf16 v[240:255], v[28:31], v[52:55], v[240:255]
    v_subrev_u32 v9, 0x20000, v9
    ds_read_b64_tr_b16 v[24:25], v9 offset:0
    ds_read_b64_tr_b16 v[26:27], v9 offset:2048
    s_waitcnt lgkmcnt(7)
    v_exp_f32 v171, v171
    v_add_f32 v60, v60, v170
    v_fma_f32 v173, v173, s12, -v46
    v_exp_f32 v172, v172
    v_mfma_f32_32x32x16_bf16 v[224:239], v[32:35], v[56:59], v[224:239]
    v_subrev_u32 v10, 0x20000, v10
    ds_read_b64_tr_b16 v[28:29], v10 offset:0
    ds_read_b64_tr_b16 v[30:31], v10 offset:2048
    v_add_u32 v12, 0x10000, v12
    ds_read_b128 v[52:55], v12 offset:0
    v_add_f32 v60, v60, v171
    v_fma_f32 v174, v174, s12, -v46
    v_exp_f32 v173, v173
    v_add_f32 v60, v60, v172
    v_mfma_f32_32x32x16_bf16 v[240:255], v[36:39], v[56:59], v[240:255]
    ds_read_b64_tr_b16 v[32:33], v9 offset:4096
    ds_read_b64_tr_b16 v[34:35], v9 offset:6144
    s_waitcnt lgkmcnt(7)
    v_fma_f32 v175, v175, s12, -v46
    v_exp_f32 v174, v174
    v_add_f32 v60, v60, v173
    v_exp_f32 v175, v175
    v_mfma_f32_32x32x16_bf16 v[224:239], v[16:19], v[48:51], v[224:239]
    ds_read_b64_tr_b16 v[36:37], v10 offset:4096
    ds_read_b64_tr_b16 v[38:39], v10 offset:6144
    ds_read_b128 v[56:59], v12 offset:1024
    v_add_f32 v60, v60, v174
    v_add_f32 v60, v60, v175
    v_sub_f32 v62, v43, v61
    v_exp_f32 v62, v62
    v_mfma_f32_32x32x16_bf16 v[240:255], v[20:23], v[48:51], v[240:255]
    ds_read_b64_tr_b16 v[16:17], v9 offset:8192
    ds_read_b64_tr_b16 v[18:19], v9 offset:10240
    s_waitcnt lgkmcnt(7)
    v_mul_f32 v112, v62, v112
    v_mul_f32 v113, v62, v113
    v_mul_f32 v114, v62, v114
    v_mul_f32 v115, v62, v115
    v_mul_f32 v116, v62, v116
    s_barrier
    v_mfma_f32_32x32x16_bf16 v[192:207], v[24:27], v[52:55], v[192:207]
    ds_read_b64_tr_b16 v[20:21], v10 offset:8192
    ds_read_b64_tr_b16 v[22:23], v10 offset:10240
    ds_read_b128 v[48:51], v12 offset:4096
    v_mul_f32 v117, v62, v117
    v_mul_f32 v118, v62, v118
    v_mul_f32 v119, v62, v119
    v_cvt_pk_bf16_f32 v112, v112, v113
    v_mfma_f32_32x32x16_bf16 v[208:223], v[28:31], v[52:55], v[208:223]
    ds_read_b64_tr_b16 v[24:25], v9 offset:12288
    ds_read_b64_tr_b16 v[26:27], v9 offset:14336
    s_waitcnt lgkmcnt(7)
    v_cvt_pk_bf16_f32 v113, v114, v115
    v_cvt_pk_bf16_f32 v114, v116, v117
    v_cvt_pk_bf16_f32 v115, v118, v119
    ds_write_b128 v14, v[112:115] offset:8192
    v_mul_f32 v120, v62, v120
    v_mfma_f32_32x32x16_bf16 v[192:207], v[32:35], v[56:59], v[192:207]
    ds_read_b64_tr_b16 v[28:29], v10 offset:12288
    ds_read_b64_tr_b16 v[30:31], v10 offset:14336
    ds_read_b128 v[52:55], v12 offset:5120
    v_mul_f32 v121, v62, v121
    v_mul_f32 v122, v62, v122
    v_mul_f32 v123, v62, v123
    v_mul_f32 v124, v62, v124
    v_mfma_f32_32x32x16_bf16 v[208:223], v[36:39], v[56:59], v[208:223]
    ds_read_b64_tr_b16 v[32:33], v9 offset:49152
    ds_read_b64_tr_b16 v[34:35], v9 offset:51200
    s_waitcnt lgkmcnt(8)
    v_mul_f32 v125, v62, v125
    v_mul_f32 v126, v62, v126
    v_mul_f32 v127, v62, v127
    v_cvt_pk_bf16_f32 v120, v120, v121
    v_cvt_pk_bf16_f32 v121, v122, v123
    v_mfma_f32_32x32x16_bf16 v[192:207], v[16:19], v[48:51], v[192:207]
    ds_read_b64_tr_b16 v[36:37], v10 offset:49152
    ds_read_b64_tr_b16 v[38:39], v10 offset:51200
    ds_read_b128 v[56:59], v12 offset:0
    v_cvt_pk_bf16_f32 v122, v124, v125
    v_cvt_pk_bf16_f32 v123, v126, v127
    ds_write_b128 v14, v[120:123] offset:9216
    v_max_f32 v40, v40, v63
    v_mfma_f32_32x32x16_bf16 v[208:223], v[20:23], v[48:51], v[208:223]
    ds_read_b64_tr_b16 v[16:17], v9 offset:53248
    ds_read_b64_tr_b16 v[18:19], v9 offset:55296
    s_waitcnt lgkmcnt(8)
    v_mul_f32 v40, s12, v40
    v_max_f32 v40, v40, v61
    v_sub_f32 v47, v61, v40
    v_exp_f32 v47, v47
    v_mfma_f32_32x32x16_bf16 v[192:207], v[24:27], v[52:55], v[192:207]
    ds_read_b64_tr_b16 v[20:21], v10 offset:53248
    ds_read_b64_tr_b16 v[22:23], v10 offset:55296
    ds_read_b128 v[48:51], v12 offset:1024
    v_sub_f32 v62, v46, v40
    v_exp_f32 v62, v62
    v_fma_f32 v176, v176, s12, -v40
    v_mfma_f32_32x32x16_bf16 v[208:223], v[28:31], v[52:55], v[208:223]
    ds_read_b64_tr_b16 v[24:25], v9 offset:57344
    ds_read_b64_tr_b16 v[26:27], v9 offset:59392
    s_waitcnt lgkmcnt(8)
    v_fma_f32 v177, v177, s12, -v40
    v_exp_f32 v176, v176
    v_fma_f32 v178, v178, s12, -v40
    s_waitcnt lgkmcnt(7)
    s_barrier
    v_mfma_f32_32x32x16_bf16 v[224:239], v[32:35], v[56:59], v[224:239]
    ds_read_b64_tr_b16 v[28:29], v10 offset:57344
    ds_read_b64_tr_b16 v[30:31], v10 offset:59392
    ds_read_b128 v[52:55], v12 offset:4096
    v_exp_f32 v177, v177
    v_fma_f32 v60, v60, v62, v176
    v_fma_f32 v179, v179, s12, -v40
    v_mfma_f32_32x32x16_bf16 v[240:255], v[36:39], v[56:59], v[240:255]
    ds_read_b64_tr_b16 v[32:33], v9 offset:61440
    ds_read_b64_tr_b16 v[34:35], v9 offset:63488
    s_waitcnt lgkmcnt(7)
    v_exp_f32 v178, v178
    v_add_f32 v60, v60, v177
    v_fma_f32 v180, v180, s12, -v40
    v_exp_f32 v179, v179
    v_mfma_f32_32x32x16_bf16 v[224:239], v[16:19], v[48:51], v[224:239]
    ds_read_b64_tr_b16 v[36:37], v10 offset:61440
    ds_read_b64_tr_b16 v[38:39], v10 offset:63488
    ds_read_b128 v[56:59], v12 offset:5120
    v_add_f32 v60, v60, v178
    v_fma_f32 v181, v181, s12, -v40
    v_exp_f32 v180, v180
    v_mfma_f32_32x32x16_bf16 v[240:255], v[20:23], v[48:51], v[240:255]
    v_add_u32 v9, 0x10000, v9
    ds_read_b64_tr_b16 v[16:17], v9 offset:16384
    ds_read_b64_tr_b16 v[18:19], v9 offset:18432
    s_waitcnt lgkmcnt(7)
    v_add_f32 v60, v60, v179
    v_fma_f32 v182, v182, s12, -v40
    v_exp_f32 v181, v181
    v_add_f32 v60, v60, v180
    v_mfma_f32_32x32x16_bf16 v[224:239], v[24:27], v[52:55], v[224:239]
    v_add_u32 v10, 0x10000, v10
    ds_read_b64_tr_b16 v[20:21], v10 offset:16384
    ds_read_b64_tr_b16 v[22:23], v10 offset:18432
    ds_read_b128 v[48:51], v12 offset:8192
    v_fma_f32 v183, v183, s12, -v40
    v_exp_f32 v182, v182
    v_add_f32 v60, v60, v181
    v_mfma_f32_32x32x16_bf16 v[240:255], v[28:31], v[52:55], v[240:255]
    ds_read_b64_tr_b16 v[24:25], v9 offset:20480
    ds_read_b64_tr_b16 v[26:27], v9 offset:22528
    s_waitcnt lgkmcnt(7)
    v_fma_f32 v184, v184, s12, -v40
    v_exp_f32 v183, v183
    v_add_f32 v60, v60, v182
    v_fma_f32 v185, v185, s12, -v40
    v_mfma_f32_32x32x16_bf16 v[224:239], v[32:35], v[56:59], v[224:239]
    ds_read_b64_tr_b16 v[28:29], v10 offset:20480
    ds_read_b64_tr_b16 v[30:31], v10 offset:22528
    ds_read_b128 v[52:55], v12 offset:9216
    v_exp_f32 v184, v184
    v_add_f32 v60, v60, v183
    v_fma_f32 v186, v186, s12, -v40
    v_mfma_f32_32x32x16_bf16 v[240:255], v[36:39], v[56:59], v[240:255]
    ds_read_b64_tr_b16 v[32:33], v9 offset:24576
    ds_read_b64_tr_b16 v[34:35], v9 offset:26624
    s_waitcnt lgkmcnt(7)
    v_exp_f32 v185, v185
    v_add_f32 v60, v60, v184
    v_sub_f32 v62, v44, v61
    s_barrier
    v_mfma_f32_32x32x16_bf16 v[192:207], v[16:19], v[48:51], v[192:207]
    ds_read_b64_tr_b16 v[36:37], v10 offset:24576
    ds_read_b64_tr_b16 v[38:39], v10 offset:26624
    ds_read_b128 v[56:59], v12 offset:12288
    v_exp_f32 v62, v62
    s_nop 0
    v_mul_f32 v128, v62, v128
    v_mul_f32 v129, v62, v129
    v_mul_f32 v130, v62, v130
    v_mfma_f32_32x32x16_bf16 v[208:223], v[20:23], v[48:51], v[208:223]
    ds_read_b64_tr_b16 v[16:17], v9 offset:28672
    ds_read_b64_tr_b16 v[18:19], v9 offset:30720
    s_waitcnt lgkmcnt(7)
    v_mul_f32 v131, v62, v131
    v_mul_f32 v132, v62, v132
    v_mul_f32 v133, v62, v133
    v_mul_f32 v134, v62, v134
    v_mul_f32 v135, v62, v135
    v_mfma_f32_32x32x16_bf16 v[192:207], v[24:27], v[52:55], v[192:207]
    ds_read_b64_tr_b16 v[20:21], v10 offset:28672
    ds_read_b64_tr_b16 v[22:23], v10 offset:30720
    ds_read_b128 v[48:51], v12 offset:13312
    v_cvt_pk_bf16_f32 v128, v128, v129
    v_cvt_pk_bf16_f32 v129, v130, v131
    v_cvt_pk_bf16_f32 v130, v132, v133
    v_cvt_pk_bf16_f32 v131, v134, v135
    v_mfma_f32_32x32x16_bf16 v[208:223], v[28:31], v[52:55], v[208:223]
    ds_read_b64_tr_b16 v[24:25], v9 offset:32768
    ds_read_b64_tr_b16 v[26:27], v9 offset:34816
    s_waitcnt lgkmcnt(7)
    v_subrev_u32 v14, 0x10000, v14
    ds_write_b128 v14, v[128:131] offset:16384
    v_mul_f32 v136, v62, v136
    v_mul_f32 v137, v62, v137
    v_mul_f32 v138, v62, v138
    v_mul_f32 v139, v62, v139
    v_mfma_f32_32x32x16_bf16 v[192:207], v[32:35], v[56:59], v[192:207]
    ds_read_b64_tr_b16 v[28:29], v10 offset:32768
    ds_read_b64_tr_b16 v[30:31], v10 offset:34816
    ds_read_b128 v[52:55], v12 offset:8192
    v_mul_f32 v140, v62, v140
    v_mul_f32 v141, v62, v141
    v_mul_f32 v142, v62, v142
    v_mul_f32 v143, v62, v143
    v_mfma_f32_32x32x16_bf16 v[208:223], v[36:39], v[56:59], v[208:223]
    ds_read_b64_tr_b16 v[32:33], v9 offset:36864
    ds_read_b64_tr_b16 v[34:35], v9 offset:38912
    s_waitcnt lgkmcnt(8)
    v_cvt_pk_bf16_f32 v136, v136, v137
    v_cvt_pk_bf16_f32 v137, v138, v139
    v_cvt_pk_bf16_f32 v138, v140, v141
    v_cvt_pk_bf16_f32 v139, v142, v143
    ds_write_b128 v14, v[136:139] offset:17408
    v_mfma_f32_32x32x16_bf16 v[192:207], v[16:19], v[48:51], v[192:207]
    ds_read_b64_tr_b16 v[36:37], v10 offset:36864
    ds_read_b64_tr_b16 v[38:39], v10 offset:38912
    ds_read_b128 v[56:59], v12 offset:9216
    v_fma_f32 v187, v187, s12, -v40
    v_exp_f32 v186, v186
    v_add_f32 v60, v60, v185
    v_mfma_f32_32x32x16_bf16 v[208:223], v[20:23], v[48:51], v[208:223]
    ds_read_b64_tr_b16 v[16:17], v9 offset:40960
    ds_read_b64_tr_b16 v[18:19], v9 offset:43008
    s_waitcnt lgkmcnt(8)
    v_fma_f32 v188, v188, s12, -v40
    v_exp_f32 v187, v187
    v_add_f32 v60, v60, v186
    v_fma_f32 v189, v189, s12, -v40
    s_waitcnt lgkmcnt(5)
    s_barrier
    v_mfma_f32_32x32x16_bf16 v[224:239], v[24:27], v[52:55], v[224:239]
    ds_read_b64_tr_b16 v[20:21], v10 offset:40960
    ds_read_b64_tr_b16 v[22:23], v10 offset:43008
    ds_read_b128 v[48:51], v12 offset:12288
    v_exp_f32 v188, v188
    v_add_f32 v60, v60, v187
    v_fma_f32 v190, v190, s12, -v40
    v_mfma_f32_32x32x16_bf16 v[240:255], v[28:31], v[52:55], v[240:255]
    ds_read_b64_tr_b16 v[24:25], v9 offset:45056
    ds_read_b64_tr_b16 v[26:27], v9 offset:47104
    s_waitcnt lgkmcnt(7)
    v_exp_f32 v189, v189
    v_add_f32 v60, v60, v188
    v_fma_f32 v191, v191, s12, -v40
    v_mfma_f32_32x32x16_bf16 v[224:239], v[32:35], v[56:59], v[224:239]
    ds_read_b64_tr_b16 v[28:29], v10 offset:45056
    ds_read_b64_tr_b16 v[30:31], v10 offset:47104
    ds_read_b128 v[52:55], v12 offset:13312
    v_exp_f32 v190, v190
    v_add_f32 v60, v60, v189
    v_mfma_f32_32x32x16_bf16 v[240:255], v[36:39], v[56:59], v[240:255]
    v_add_u32 v9, 0x10000, v9
    ds_read_b64_tr_b16 v[32:33], v9 offset:0
    ds_read_b64_tr_b16 v[34:35], v9 offset:2048
    s_waitcnt lgkmcnt(7)
    v_exp_f32 v191, v191
    v_add_f32 v60, v60, v190
    v_add_f32 v60, v60, v191
    v_mov_b32 v15, v60
    v_mfma_f32_32x32x16_bf16 v[224:239], v[16:19], v[48:51], v[224:239]
    v_add_u32 v10, 0x10000, v10
    ds_read_b64_tr_b16 v[36:37], v10 offset:0
    ds_read_b64_tr_b16 v[38:39], v10 offset:2048
    v_subrev_u32 v12, 0x10000, v12
    ds_read_b128 v[56:59], v12 offset:16384
    v_mov_b32 v63, v60
    s_nop 0
    s_nop 0
    v_permlane32_swap_b32 v15, v63
    v_add_f32 v63, v63, v15
    v_mfma_f32_32x32x16_bf16 v[240:255], v[20:23], v[48:51], v[240:255]
    ds_read_b64_tr_b16 v[16:17], v9 offset:4096
    ds_read_b64_tr_b16 v[18:19], v9 offset:6144
    s_waitcnt lgkmcnt(7)
    ds_write_b32 v13, v63 offset:1024
    v_sub_f32 v62, v45, v61
    v_exp_f32 v62, v62
    s_nop 0
    v_mul_f32 v144, v62, v144
    v_mfma_f32_32x32x16_bf16 v[224:239], v[24:27], v[52:55], v[224:239]
    ds_read_b64_tr_b16 v[20:21], v10 offset:4096
    ds_read_b64_tr_b16 v[22:23], v10 offset:6144
    ds_read_b128 v[48:51], v12 offset:17408
    v_mul_f32 v145, v62, v145
    v_mul_f32 v146, v62, v146
    v_mul_f32 v147, v62, v147
    v_mul_f32 v148, v62, v148
    v_mfma_f32_32x32x16_bf16 v[240:255], v[28:31], v[52:55], v[240:255]
    ds_read_b64_tr_b16 v[24:25], v9 offset:8192
    ds_read_b64_tr_b16 v[26:27], v9 offset:10240
    s_waitcnt lgkmcnt(8)
    v_mul_f32 v149, v62, v149
    v_mul_f32 v150, v62, v150
    v_mul_f32 v151, v62, v151
    v_cvt_pk_bf16_f32 v144, v144, v145
    v_cvt_pk_bf16_f32 v145, v146, v147
    s_barrier
    v_mfma_f32_32x32x16_bf16 v[192:207], v[32:35], v[56:59], v[192:207]
    ds_read_b64_tr_b16 v[28:29], v10 offset:8192
    ds_read_b64_tr_b16 v[30:31], v10 offset:10240
    ds_read_b128 v[52:55], v12 offset:20480
    v_cvt_pk_bf16_f32 v146, v148, v149
    v_cvt_pk_bf16_f32 v147, v150, v151
    ds_write_b128 v14, v[144:147] offset:24576
    v_mul_f32 v152, v62, v152
    v_mfma_f32_32x32x16_bf16 v[208:223], v[36:39], v[56:59], v[208:223]
    ds_read_b64_tr_b16 v[32:33], v9 offset:12288
    ds_read_b64_tr_b16 v[34:35], v9 offset:14336
    s_waitcnt lgkmcnt(8)
    v_mul_f32 v153, v62, v153
    v_mul_f32 v154, v62, v154
    v_mul_f32 v155, v62, v155
    v_mul_f32 v156, v62, v156
    v_mul_f32 v157, v62, v157
    v_mfma_f32_32x32x16_bf16 v[192:207], v[16:19], v[48:51], v[192:207]
    ds_read_b64_tr_b16 v[36:37], v10 offset:12288
    ds_read_b64_tr_b16 v[38:39], v10 offset:14336
    ds_read_b128 v[56:59], v12 offset:21504
    v_mul_f32 v158, v62, v158
    v_mul_f32 v159, v62, v159
    v_cvt_pk_bf16_f32 v152, v152, v153
    v_cvt_pk_bf16_f32 v153, v154, v155
    v_mfma_f32_32x32x16_bf16 v[208:223], v[20:23], v[48:51], v[208:223]
    v_subrev_u32 v9, 0x20000, v9
    ds_read_b64_tr_b16 v[16:17], v9 offset:32768
    ds_read_b64_tr_b16 v[18:19], v9 offset:34816
    s_waitcnt lgkmcnt(8)
    v_cvt_pk_bf16_f32 v154, v156, v157
    v_cvt_pk_bf16_f32 v155, v158, v159
    ds_write_b128 v14, v[152:155] offset:25600
    v_mfma_f32_32x32x16_bf16 v[192:207], v[24:27], v[52:55], v[192:207]
    v_subrev_u32 v10, 0x20000, v10
    ds_read_b64_tr_b16 v[20:21], v10 offset:32768
    ds_read_b64_tr_b16 v[22:23], v10 offset:34816
    ds_read_b128 v[48:51], v12 offset:16384
    v_mfma_f32_32x32x16_bf16 v[208:223], v[28:31], v[52:55], v[208:223]
    ds_read_b64_tr_b16 v[24:25], v9 offset:36864
    ds_read_b64_tr_b16 v[26:27], v9 offset:38912
    s_waitcnt lgkmcnt(8)
    v_mfma_f32_32x32x16_bf16 v[192:207], v[32:35], v[56:59], v[192:207]
    ds_read_b64_tr_b16 v[28:29], v10 offset:36864
    ds_read_b64_tr_b16 v[30:31], v10 offset:38912
    ds_read_b128 v[52:55], v12 offset:17408
    v_mfma_f32_32x32x16_bf16 v[208:223], v[36:39], v[56:59], v[208:223]
    ds_read_b64_tr_b16 v[32:33], v9 offset:40960
    ds_read_b64_tr_b16 v[34:35], v9 offset:43008
    s_waitcnt lgkmcnt(7)
    s_barrier
    v_mfma_f32_32x32x16_bf16 v[224:239], v[16:19], v[48:51], v[224:239]
    ds_read_b64_tr_b16 v[36:37], v10 offset:40960
    ds_read_b64_tr_b16 v[38:39], v10 offset:43008
    ds_read_b128 v[56:59], v12 offset:20480
    v_xor_b32 v15, 128, v13
    ds_read_b32 v60, v15 offset:1024
    v_sub_f32 v62, v46, v40
    v_mfma_f32_32x32x16_bf16 v[240:255], v[20:23], v[48:51], v[240:255]
    ds_read_b64_tr_b16 v[16:17], v9 offset:45056
    ds_read_b64_tr_b16 v[18:19], v9 offset:47104
    s_waitcnt lgkmcnt(8)
    v_exp_f32 v62, v62
    s_waitcnt lgkmcnt(2)
    v_add_f32 v60, v60, v63
    v_rcp_f32 v60, v60
    v_mfma_f32_32x32x16_bf16 v[224:239], v[24:27], v[52:55], v[224:239]
    ds_read_b64_tr_b16 v[20:21], v10 offset:45056
    ds_read_b64_tr_b16 v[22:23], v10 offset:47104
    ds_read_b128 v[48:51], v12 offset:21504
    v_mul_f32 v47, v47, v60
    v_mul_f32 v62, v62, v60
    v_mul_f32 v160, v62, v160
    v_mul_f32 v161, v62, v161
    v_mfma_f32_32x32x16_bf16 v[240:255], v[28:31], v[52:55], v[240:255]
    v_add_u32 v9, 0x20000, v9
    ds_read_b64_tr_b16 v[24:25], v9 offset:16384
    ds_read_b64_tr_b16 v[26:27], v9 offset:18432
    v_mul_f32 v162, v62, v162
    v_mul_f32 v163, v62, v163
    v_mul_f32 v164, v62, v164
    v_mul_f32 v165, v62, v165
    v_mul_f32 v166, v62, v166
    v_mfma_f32_32x32x16_bf16 v[224:239], v[32:35], v[56:59], v[224:239]
    v_add_u32 v10, 0x20000, v10
    ds_read_b64_tr_b16 v[28:29], v10 offset:16384
    ds_read_b64_tr_b16 v[30:31], v10 offset:18432
    ds_read_b128 v[52:55], v12 offset:24576
    v_mul_f32 v167, v62, v167
    v_cvt_pk_bf16_f32 v160, v160, v161
    v_cvt_pk_bf16_f32 v161, v162, v163
    v_cvt_pk_bf16_f32 v162, v164, v165
    v_mfma_f32_32x32x16_bf16 v[240:255], v[36:39], v[56:59], v[240:255]
    ds_read_b64_tr_b16 v[32:33], v9 offset:20480
    ds_read_b64_tr_b16 v[34:35], v9 offset:22528
    s_waitcnt lgkmcnt(7)
    v_cvt_pk_bf16_f32 v163, v166, v167
    v_add_u32 v14, 0x10000, v14
    ds_write_b128 v14, v[160:163] offset:0
    v_mul_f32 v168, v62, v168
    v_mul_f32 v169, v62, v169
    v_mul_f32 v170, v62, v170
    v_mfma_f32_32x32x16_bf16 v[224:239], v[16:19], v[48:51], v[224:239]
    ds_read_b64_tr_b16 v[36:37], v10 offset:20480
    ds_read_b64_tr_b16 v[38:39], v10 offset:22528
    ds_read_b128 v[56:59], v12 offset:25600
    v_mul_f32 v171, v62, v171
    v_mul_f32 v172, v62, v172
    v_mul_f32 v173, v62, v173
    v_mul_f32 v174, v62, v174
    v_mfma_f32_32x32x16_bf16 v[240:255], v[20:23], v[48:51], v[240:255]
    ds_read_b64_tr_b16 v[16:17], v9 offset:24576
    ds_read_b64_tr_b16 v[18:19], v9 offset:26624
    s_waitcnt lgkmcnt(8)
    v_mul_f32 v175, v62, v175
    v_cvt_pk_bf16_f32 v168, v168, v169
    v_cvt_pk_bf16_f32 v169, v170, v171
    v_cvt_pk_bf16_f32 v170, v172, v173
    v_cvt_pk_bf16_f32 v171, v174, v175
    s_barrier
    v_mfma_f32_32x32x16_bf16 v[192:207], v[24:27], v[52:55], v[192:207]
    ds_read_b64_tr_b16 v[20:21], v10 offset:24576
    ds_read_b64_tr_b16 v[22:23], v10 offset:26624
    ds_read_b128 v[48:51], v12 offset:28672
    ds_write_b128 v14, v[168:171] offset:1024
    v_mul_f32 v176, v60, v176
    v_mul_f32 v177, v60, v177
    v_mul_f32 v178, v60, v178
    v_mfma_f32_32x32x16_bf16 v[208:223], v[28:31], v[52:55], v[208:223]
    ds_read_b64_tr_b16 v[24:25], v9 offset:28672
    ds_read_b64_tr_b16 v[26:27], v9 offset:30720
    s_waitcnt lgkmcnt(8)
    v_mul_f32 v179, v60, v179
    v_mul_f32 v180, v60, v180
    v_mul_f32 v181, v60, v181
    v_mul_f32 v182, v60, v182
    v_mul_f32 v183, v60, v183
    v_mfma_f32_32x32x16_bf16 v[192:207], v[32:35], v[56:59], v[192:207]
    ds_read_b64_tr_b16 v[28:29], v10 offset:28672
    ds_read_b64_tr_b16 v[30:31], v10 offset:30720
    ds_read_b128 v[52:55], v12 offset:29696
    v_cvt_pk_bf16_f32 v176, v176, v177
    v_cvt_pk_bf16_f32 v177, v178, v179
    v_cvt_pk_bf16_f32 v178, v180, v181
    v_cvt_pk_bf16_f32 v179, v182, v183
    v_mfma_f32_32x32x16_bf16 v[208:223], v[36:39], v[56:59], v[208:223]
    v_subrev_u32 v9, 0x20000, v9
    ds_read_b64_tr_b16 v[32:33], v9 offset:0
    ds_read_b64_tr_b16 v[34:35], v9 offset:2048
    s_waitcnt lgkmcnt(8)
    ds_write_b128 v14, v[176:179] offset:8192
    v_mul_f32 v184, v60, v184
    v_mul_f32 v185, v60, v185
    v_mul_f32 v186, v60, v186
    v_mul_f32 v187, v60, v187
    v_mfma_f32_32x32x16_bf16 v[192:207], v[16:19], v[48:51], v[192:207]
    v_subrev_u32 v10, 0x20000, v10
    ds_read_b64_tr_b16 v[36:37], v10 offset:0
    ds_read_b64_tr_b16 v[38:39], v10 offset:2048
    ds_read_b128 v[56:59], v12 offset:24576
    v_mul_f32 v188, v60, v188
    v_mul_f32 v189, v60, v189
    v_mul_f32 v190, v60, v190
    v_mul_f32 v191, v60, v191
    v_mfma_f32_32x32x16_bf16 v[208:223], v[20:23], v[48:51], v[208:223]
    ds_read_b64_tr_b16 v[16:17], v9 offset:4096
    ds_read_b64_tr_b16 v[18:19], v9 offset:6144
    s_waitcnt lgkmcnt(8)
    v_cvt_pk_bf16_f32 v184, v184, v185
    v_cvt_pk_bf16_f32 v185, v186, v187
    v_cvt_pk_bf16_f32 v186, v188, v189
    v_cvt_pk_bf16_f32 v187, v190, v191
    ds_write_b128 v14, v[184:187] offset:9216
    v_mfma_f32_32x32x16_bf16 v[192:207], v[24:27], v[52:55], v[192:207]
    ds_read_b64_tr_b16 v[20:21], v10 offset:4096
    ds_read_b64_tr_b16 v[22:23], v10 offset:6144
    ds_read_b128 v[48:51], v12 offset:25600
    s_waitcnt vmcnt(0)
    v_subrev_u32 v14, 0x10000, v14
    v_mfma_f32_32x32x16_bf16 v[208:223], v[28:31], v[52:55], v[208:223]
    ds_read_b64_tr_b16 v[24:25], v9 offset:8192
    ds_read_b64_tr_b16 v[26:27], v9 offset:10240
    s_waitcnt lgkmcnt(8)
    s_barrier
    v_mfma_f32_32x32x16_bf16 v[224:239], v[32:35], v[56:59], v[224:239]
    ds_read_b64_tr_b16 v[28:29], v10 offset:8192
    ds_read_b64_tr_b16 v[30:31], v10 offset:10240
    ds_read_b128 v[52:55], v12 offset:28672
    v_mfma_f32_32x32x16_bf16 v[240:255], v[36:39], v[56:59], v[240:255]
    ds_read_b64_tr_b16 v[32:33], v9 offset:12288
    ds_read_b64_tr_b16 v[34:35], v9 offset:14336
    s_waitcnt lgkmcnt(7)
    v_mfma_f32_32x32x16_bf16 v[224:239], v[16:19], v[48:51], v[224:239]
    ds_read_b64_tr_b16 v[36:37], v10 offset:12288
    ds_read_b64_tr_b16 v[38:39], v10 offset:14336
    ds_read_b128 v[56:59], v12 offset:29696
    v_mul_f32 v192, v47, v192
    v_mul_f32 v193, v47, v193
    v_mul_f32 v194, v47, v194
    v_mul_f32 v195, v47, v195
    v_mul_f32 v196, v47, v196
    v_mfma_f32_32x32x16_bf16 v[240:255], v[20:23], v[48:51], v[240:255]
    ds_read_b64_tr_b16 v[16:17], v9 offset:49152
    ds_read_b64_tr_b16 v[18:19], v9 offset:51200
    s_waitcnt lgkmcnt(7)
    v_mul_f32 v197, v47, v197
    v_mul_f32 v198, v47, v198
    v_mul_f32 v199, v47, v199
    v_mul_f32 v200, v47, v200
    v_mul_f32 v201, v47, v201
    v_mul_f32 v202, v47, v202
    v_mfma_f32_32x32x16_bf16 v[224:239], v[24:27], v[52:55], v[224:239]
    ds_read_b64_tr_b16 v[20:21], v10 offset:49152
    ds_read_b64_tr_b16 v[22:23], v10 offset:51200
    v_add_u32 v12, 0x10000, v12
    ds_read_b128 v[48:51], v12 offset:0
    v_mul_f32 v203, v47, v203
    v_mul_f32 v204, v47, v204
    v_mul_f32 v205, v47, v205
    v_mul_f32 v206, v47, v206
    v_mul_f32 v207, v47, v207
    v_mfma_f32_32x32x16_bf16 v[240:255], v[28:31], v[52:55], v[240:255]
    ds_read_b64_tr_b16 v[24:25], v9 offset:53248
    ds_read_b64_tr_b16 v[26:27], v9 offset:55296
    s_waitcnt lgkmcnt(7)
    v_mul_f32 v208, v47, v208
    v_mul_f32 v209, v47, v209
    v_mul_f32 v210, v47, v210
    v_mul_f32 v211, v47, v211
    v_mul_f32 v212, v47, v212
    v_mul_f32 v213, v47, v213
    v_mfma_f32_32x32x16_bf16 v[224:239], v[32:35], v[56:59], v[224:239]
    ds_read_b64_tr_b16 v[28:29], v10 offset:53248
    ds_read_b64_tr_b16 v[30:31], v10 offset:55296
    ds_read_b128 v[52:55], v12 offset:1024
    v_mul_f32 v214, v47, v214
    v_mul_f32 v215, v47, v215
    v_mul_f32 v216, v47, v216
    v_mul_f32 v217, v47, v217
    v_mul_f32 v218, v47, v218
    v_mfma_f32_32x32x16_bf16 v[240:255], v[36:39], v[56:59], v[240:255]
    ds_read_b64_tr_b16 v[32:33], v9 offset:57344
    ds_read_b64_tr_b16 v[34:35], v9 offset:59392
    s_waitcnt lgkmcnt(7)
    v_mul_f32 v219, v47, v219
    v_mul_f32 v220, v47, v220
    v_mul_f32 v221, v47, v221
    v_mul_f32 v222, v47, v222
    v_mul_f32 v223, v47, v223
    s_barrier
    v_mfma_f32_32x32x16_bf16 v[192:207], v[16:19], v[48:51], v[192:207]
    ds_read_b64_tr_b16 v[36:37], v10 offset:57344
    ds_read_b64_tr_b16 v[38:39], v10 offset:59392
    ds_read_b128 v[56:59], v12 offset:4096
    v_mfma_f32_32x32x16_bf16 v[208:223], v[20:23], v[48:51], v[208:223]
    ds_read_b64_tr_b16 v[16:17], v9 offset:61440
    ds_read_b64_tr_b16 v[18:19], v9 offset:63488
    s_waitcnt lgkmcnt(7)
    v_mfma_f32_32x32x16_bf16 v[192:207], v[24:27], v[52:55], v[192:207]
    ds_read_b64_tr_b16 v[20:21], v10 offset:61440
    ds_read_b64_tr_b16 v[22:23], v10 offset:63488
    ds_read_b128 v[48:51], v12 offset:5120
    v_mul_f32 v224, v47, v224
    v_mul_f32 v225, v47, v225
    v_mul_f32 v226, v47, v226
    v_mul_f32 v227, v47, v227
    v_mul_f32 v228, v47, v228
    v_mfma_f32_32x32x16_bf16 v[208:223], v[28:31], v[52:55], v[208:223]
    v_add_u32 v9, 0x10000, v9
    ds_read_b64_tr_b16 v[24:25], v9 offset:16384
    ds_read_b64_tr_b16 v[26:27], v9 offset:18432
    s_waitcnt lgkmcnt(7)
    v_mul_f32 v229, v47, v229
    v_mul_f32 v230, v47, v230
    v_mul_f32 v231, v47, v231
    v_mul_f32 v232, v47, v232
    v_mul_f32 v233, v47, v233
    v_mul_f32 v234, v47, v234
    v_mfma_f32_32x32x16_bf16 v[192:207], v[32:35], v[56:59], v[192:207]
    v_add_u32 v10, 0x10000, v10
    ds_read_b64_tr_b16 v[28:29], v10 offset:16384
    ds_read_b64_tr_b16 v[30:31], v10 offset:18432
    ds_read_b128 v[52:55], v12 offset:0
    v_mul_f32 v235, v47, v235
    v_mul_f32 v236, v47, v236
    v_mul_f32 v237, v47, v237
    v_mul_f32 v238, v47, v238
    v_mul_f32 v239, v47, v239
    v_mfma_f32_32x32x16_bf16 v[208:223], v[36:39], v[56:59], v[208:223]
    ds_read_b64_tr_b16 v[32:33], v9 offset:20480
    ds_read_b64_tr_b16 v[34:35], v9 offset:22528
    s_waitcnt lgkmcnt(7)
    v_mul_f32 v240, v47, v240
    v_mul_f32 v241, v47, v241
    v_mul_f32 v242, v47, v242
    v_mul_f32 v243, v47, v243
    v_mul_f32 v244, v47, v244
    v_mul_f32 v245, v47, v245
    v_mfma_f32_32x32x16_bf16 v[192:207], v[16:19], v[48:51], v[192:207]
    ds_read_b64_tr_b16 v[36:37], v10 offset:20480
    ds_read_b64_tr_b16 v[38:39], v10 offset:22528
    ds_read_b128 v[56:59], v12 offset:1024
    v_mul_f32 v246, v47, v246
    v_mul_f32 v247, v47, v247
    v_mul_f32 v248, v47, v248
    v_mul_f32 v249, v47, v249
    v_mul_f32 v250, v47, v250
    v_mfma_f32_32x32x16_bf16 v[208:223], v[20:23], v[48:51], v[208:223]
    ds_read_b64_tr_b16 v[16:17], v9 offset:24576
    ds_read_b64_tr_b16 v[18:19], v9 offset:26624
    s_waitcnt lgkmcnt(7)
    v_mul_f32 v251, v47, v251
    v_mul_f32 v252, v47, v252
    v_mul_f32 v253, v47, v253
    v_mul_f32 v254, v47, v254
    v_mul_f32 v255, v47, v255
    s_barrier
    v_mfma_f32_32x32x16_bf16 v[224:239], v[24:27], v[52:55], v[224:239]
    ds_read_b64_tr_b16 v[20:21], v10 offset:24576
    ds_read_b64_tr_b16 v[22:23], v10 offset:26624
    ds_read_b128 v[48:51], v12 offset:4096
    v_mfma_f32_32x32x16_bf16 v[240:255], v[28:31], v[52:55], v[240:255]
    ds_read_b64_tr_b16 v[24:25], v9 offset:28672
    ds_read_b64_tr_b16 v[26:27], v9 offset:30720
    s_waitcnt lgkmcnt(7)
    v_mfma_f32_32x32x16_bf16 v[224:239], v[32:35], v[56:59], v[224:239]
    ds_read_b64_tr_b16 v[28:29], v10 offset:28672
    ds_read_b64_tr_b16 v[30:31], v10 offset:30720
    ds_read_b128 v[52:55], v12 offset:5120
    v_mfma_f32_32x32x16_bf16 v[240:255], v[36:39], v[56:59], v[240:255]
    ds_read_b64_tr_b16 v[32:33], v9 offset:32768
    ds_read_b64_tr_b16 v[34:35], v9 offset:34816
    s_waitcnt lgkmcnt(7)
    v_mfma_f32_32x32x16_bf16 v[224:239], v[16:19], v[48:51], v[224:239]
    ds_read_b64_tr_b16 v[36:37], v10 offset:32768
    ds_read_b64_tr_b16 v[38:39], v10 offset:34816
    ds_read_b128 v[56:59], v12 offset:8192
    v_mfma_f32_32x32x16_bf16 v[240:255], v[20:23], v[48:51], v[240:255]
    ds_read_b64_tr_b16 v[16:17], v9 offset:36864
    ds_read_b64_tr_b16 v[18:19], v9 offset:38912
    s_waitcnt lgkmcnt(7)
    v_mfma_f32_32x32x16_bf16 v[224:239], v[24:27], v[52:55], v[224:239]
    ds_read_b64_tr_b16 v[20:21], v10 offset:36864
    ds_read_b64_tr_b16 v[22:23], v10 offset:38912
    ds_read_b128 v[48:51], v12 offset:9216
    v_mfma_f32_32x32x16_bf16 v[240:255], v[28:31], v[52:55], v[240:255]
    ds_read_b64_tr_b16 v[24:25], v9 offset:40960
    ds_read_b64_tr_b16 v[26:27], v9 offset:43008
    s_waitcnt lgkmcnt(7)
    s_barrier
    v_mfma_f32_32x32x16_bf16 v[192:207], v[32:35], v[56:59], v[192:207]
    ds_read_b64_tr_b16 v[28:29], v10 offset:40960
    ds_read_b64_tr_b16 v[30:31], v10 offset:43008
    ds_read_b128 v[52:55], v12 offset:12288
    v_mfma_f32_32x32x16_bf16 v[208:223], v[36:39], v[56:59], v[208:223]
    ds_read_b64_tr_b16 v[32:33], v9 offset:45056
    ds_read_b64_tr_b16 v[34:35], v9 offset:47104
    s_waitcnt lgkmcnt(7)
    v_mfma_f32_32x32x16_bf16 v[192:207], v[16:19], v[48:51], v[192:207]
    ds_read_b64_tr_b16 v[36:37], v10 offset:45056
    ds_read_b64_tr_b16 v[38:39], v10 offset:47104
    ds_read_b128 v[56:59], v12 offset:13312
    v_mfma_f32_32x32x16_bf16 v[208:223], v[20:23], v[48:51], v[208:223]
    v_add_u32 v9, 0x10000, v9
    ds_read_b64_tr_b16 v[16:17], v9 offset:0
    ds_read_b64_tr_b16 v[18:19], v9 offset:2048
    s_waitcnt lgkmcnt(7)
    v_mfma_f32_32x32x16_bf16 v[192:207], v[24:27], v[52:55], v[192:207]
    v_add_u32 v10, 0x10000, v10
    ds_read_b64_tr_b16 v[20:21], v10 offset:0
    ds_read_b64_tr_b16 v[22:23], v10 offset:2048
    ds_read_b128 v[48:51], v12 offset:8192
    v_mfma_f32_32x32x16_bf16 v[208:223], v[28:31], v[52:55], v[208:223]
    ds_read_b64_tr_b16 v[24:25], v9 offset:4096
    ds_read_b64_tr_b16 v[26:27], v9 offset:6144
    s_waitcnt lgkmcnt(7)
    v_mfma_f32_32x32x16_bf16 v[192:207], v[32:35], v[56:59], v[192:207]
    ds_read_b64_tr_b16 v[28:29], v10 offset:4096
    ds_read_b64_tr_b16 v[30:31], v10 offset:6144
    ds_read_b128 v[52:55], v12 offset:9216
    v_mfma_f32_32x32x16_bf16 v[208:223], v[36:39], v[56:59], v[208:223]
    ds_read_b64_tr_b16 v[32:33], v9 offset:8192
    ds_read_b64_tr_b16 v[34:35], v9 offset:10240
    s_waitcnt lgkmcnt(7)
    s_barrier
    v_mfma_f32_32x32x16_bf16 v[224:239], v[16:19], v[48:51], v[224:239]
    ds_read_b64_tr_b16 v[36:37], v10 offset:8192
    ds_read_b64_tr_b16 v[38:39], v10 offset:10240
    ds_read_b128 v[56:59], v12 offset:12288
    s_lshl_b32 s10, s9, 13
    s_add_u32 s14, s10, 0
    s_lshl_b32 s10, s8, 12
    s_add_u32 s10, s10, s14
    v_lshl_add_u32 v13, v0, 4, s10
    v_mfma_f32_32x32x16_bf16 v[240:255], v[20:23], v[48:51], v[240:255]
    ds_read_b64_tr_b16 v[16:17], v9 offset:12288
    ds_read_b64_tr_b16 v[18:19], v9 offset:14336
    s_waitcnt lgkmcnt(7)
    v_cvt_pk_bf16_f32 v192, v192, v193
    v_cvt_pk_bf16_f32 v193, v194, v195
    v_cvt_pk_bf16_f32 v194, v196, v197
    v_cvt_pk_bf16_f32 v195, v198, v199
    ds_write_b128 v13, v[192:195] offset:0
    v_mfma_f32_32x32x16_bf16 v[224:239], v[24:27], v[52:55], v[224:239]
    ds_read_b64_tr_b16 v[20:21], v10 offset:12288
    ds_read_b64_tr_b16 v[22:23], v10 offset:14336
    ds_read_b128 v[48:51], v12 offset:13312
    v_cvt_pk_bf16_f32 v200, v200, v201
    v_cvt_pk_bf16_f32 v201, v202, v203
    v_cvt_pk_bf16_f32 v202, v204, v205
    v_cvt_pk_bf16_f32 v203, v206, v207
    v_mfma_f32_32x32x16_bf16 v[240:255], v[28:31], v[52:55], v[240:255]
    v_add_u32 v11, 0x10000, v11
    ds_read_b64_tr_b16 v[24:25], v11 offset:49152
    ds_read_b64_tr_b16 v[26:27], v11 offset:50176
    s_waitcnt lgkmcnt(8)
    ds_write_b128 v13, v[200:203] offset:1024
    v_cvt_pk_bf16_f32 v208, v208, v209
    v_cvt_pk_bf16_f32 v209, v210, v211
    v_cvt_pk_bf16_f32 v210, v212, v213
    v_mfma_f32_32x32x16_bf16 v[224:239], v[32:35], v[56:59], v[224:239]
    ds_read_b64_tr_b16 v[28:29], v11 offset:51200
    ds_read_b64_tr_b16 v[30:31], v11 offset:52224
    v_cvt_pk_bf16_f32 v211, v214, v215
    ds_write_b128 v13, v[208:211] offset:2048
    v_cvt_pk_bf16_f32 v216, v216, v217
    v_mfma_f32_32x32x16_bf16 v[240:255], v[36:39], v[56:59], v[240:255]
    ds_read_b64_tr_b16 v[32:33], v11 offset:53248
    ds_read_b64_tr_b16 v[34:35], v11 offset:54272
    s_waitcnt lgkmcnt(8)
    v_cvt_pk_bf16_f32 v217, v218, v219
    v_cvt_pk_bf16_f32 v218, v220, v221
    v_cvt_pk_bf16_f32 v219, v222, v223
    ds_write_b128 v13, v[216:219] offset:3072
    v_mfma_f32_32x32x16_bf16 v[224:239], v[16:19], v[48:51], v[224:239]
    ds_read_b64_tr_b16 v[36:37], v11 offset:55296
    ds_read_b64_tr_b16 v[38:39], v11 offset:56320
    v_mfma_f32_32x32x16_bf16 v[240:255], v[20:23], v[48:51], v[240:255]
    ds_read_b64_tr_b16 v[16:17], v11 offset:57344
    ds_read_b64_tr_b16 v[18:19], v11 offset:58368
    s_waitcnt lgkmcnt(11)
    v_lshl_add_u32 v13, v0, 4, s14
    s_waitcnt lgkmcnt(4)
    s_barrier
    ds_read_b128 v[192:195], v13 offset:0
    ds_read_b128 v[196:199], v13 offset:1024
    ds_read_b128 v[200:203], v13 offset:2048
    ds_read_b128 v[204:207], v13 offset:3072
    ds_read_b128 v[208:211], v13 offset:4096
    ds_read_b128 v[212:215], v13 offset:5120
    ds_read_b128 v[216:219], v13 offset:6144
    ds_read_b128 v[220:223], v13 offset:7168
    s_waitcnt lgkmcnt(7)
    v_mfma_f32_32x32x16_bf16 v[64:79], v[24:27], v[192:195], 0
    ds_read_b64_tr_b16 v[20:21], v11 offset:59392
    ds_read_b64_tr_b16 v[22:23], v11 offset:60416
    s_waitcnt lgkmcnt(8)
    s_lshl_b32 s10, s9, 13
    s_add_u32 s14, s10, 81920
    s_lshl_b32 s10, s8, 12
    s_add_u32 s10, s10, s14
    v_lshl_add_u32 v13, v0, 4, s10
    v_mfma_f32_32x32x16_bf16 v[64:79], v[28:31], v[196:199], v[64:79]
    ds_read_b64_tr_b16 v[24:25], v11 offset:61440
    ds_read_b64_tr_b16 v[26:27], v11 offset:62464
    s_waitcnt lgkmcnt(9)
    v_mfma_f32_32x32x16_bf16 v[64:79], v[32:35], v[200:203], v[64:79]
    ds_read_b64_tr_b16 v[28:29], v11 offset:63488
    ds_read_b64_tr_b16 v[30:31], v11 offset:64512
    s_waitcnt lgkmcnt(10)
    v_cvt_pk_bf16_f32 v224, v224, v225
    v_cvt_pk_bf16_f32 v225, v226, v227
    v_cvt_pk_bf16_f32 v226, v228, v229
    v_mfma_f32_32x32x16_bf16 v[64:79], v[36:39], v[204:207], v[64:79]
    v_subrev_u32 v11, 0x10000, v11
    ds_read_b64_tr_b16 v[32:33], v11 offset:32768
    ds_read_b64_tr_b16 v[34:35], v11 offset:33792
    s_waitcnt lgkmcnt(11)
    v_cvt_pk_bf16_f32 v227, v230, v231
    ds_write_b128 v13, v[224:227] offset:0
    v_mfma_f32_32x32x16_bf16 v[64:79], v[16:19], v[208:211], v[64:79]
    ds_read_b64_tr_b16 v[36:37], v11 offset:34816
    ds_read_b64_tr_b16 v[38:39], v11 offset:35840
    s_waitcnt lgkmcnt(9)
    v_mfma_f32_32x32x16_bf16 v[64:79], v[20:23], v[212:215], v[64:79]
    ds_read_b64_tr_b16 v[16:17], v11 offset:36864
    ds_read_b64_tr_b16 v[18:19], v11 offset:37888
    s_waitcnt lgkmcnt(9)
    v_cvt_pk_bf16_f32 v232, v232, v233
    v_cvt_pk_bf16_f32 v233, v234, v235
    v_cvt_pk_bf16_f32 v234, v236, v237
    v_mfma_f32_32x32x16_bf16 v[64:79], v[24:27], v[216:219], v[64:79]
    ds_read_b64_tr_b16 v[20:21], v11 offset:38912
    ds_read_b64_tr_b16 v[22:23], v11 offset:39936
    s_waitcnt lgkmcnt(9)
    v_cvt_pk_bf16_f32 v235, v238, v239
    ds_write_b128 v13, v[232:235] offset:1024
    v_mfma_f32_32x32x16_bf16 v[64:79], v[28:31], v[220:223], v[64:79]
    ds_read_b64_tr_b16 v[24:25], v11 offset:40960
    ds_read_b64_tr_b16 v[26:27], v11 offset:41984
    s_waitcnt lgkmcnt(10)
    s_barrier
    v_mfma_f32_32x32x16_bf16 v[80:95], v[32:35], v[192:195], 0
    ds_read_b64_tr_b16 v[28:29], v11 offset:43008
    ds_read_b64_tr_b16 v[30:31], v11 offset:44032
    s_waitcnt lgkmcnt(9)
    v_cvt_pk_bf16_f32 v240, v240, v241
    v_cvt_pk_bf16_f32 v241, v242, v243
    v_cvt_pk_bf16_f32 v242, v244, v245
    v_mfma_f32_32x32x16_bf16 v[80:95], v[36:39], v[196:199], v[80:95]
    ds_read_b64_tr_b16 v[32:33], v11 offset:45056
    ds_read_b64_tr_b16 v[34:35], v11 offset:46080
    s_waitcnt lgkmcnt(9)
    v_cvt_pk_bf16_f32 v243, v246, v247
    ds_write_b128 v13, v[240:243] offset:2048
    v_mfma_f32_32x32x16_bf16 v[80:95], v[16:19], v[200:203], v[80:95]
    ds_read_b64_tr_b16 v[36:37], v11 offset:47104
    ds_read_b64_tr_b16 v[38:39], v11 offset:48128
    s_waitcnt lgkmcnt(10)
    v_mfma_f32_32x32x16_bf16 v[80:95], v[20:23], v[204:207], v[80:95]
    v_add_u32 v11, 0x20000, v11
    ds_read_b64_tr_b16 v[16:17], v11 offset:16384
    ds_read_b64_tr_b16 v[18:19], v11 offset:17408
    s_waitcnt lgkmcnt(9)
    v_cvt_pk_bf16_f32 v248, v248, v249
    v_cvt_pk_bf16_f32 v249, v250, v251
    v_cvt_pk_bf16_f32 v250, v252, v253
    v_mfma_f32_32x32x16_bf16 v[80:95], v[24:27], v[208:211], v[80:95]
    ds_read_b64_tr_b16 v[20:21], v11 offset:18432
    ds_read_b64_tr_b16 v[22:23], v11 offset:19456
    s_waitcnt lgkmcnt(9)
    v_cvt_pk_bf16_f32 v251, v254, v255
    ds_write_b128 v13, v[248:251] offset:3072
    v_mfma_f32_32x32x16_bf16 v[80:95], v[28:31], v[212:215], v[80:95]
    ds_read_b64_tr_b16 v[24:25], v11 offset:20480
    ds_read_b64_tr_b16 v[26:27], v11 offset:21504
    s_waitcnt lgkmcnt(10)
    v_mfma_f32_32x32x16_bf16 v[80:95], v[32:35], v[216:219], v[80:95]
    ds_read_b64_tr_b16 v[28:29], v11 offset:22528
    ds_read_b64_tr_b16 v[30:31], v11 offset:23552
    s_waitcnt lgkmcnt(9)
    v_mfma_f32_32x32x16_bf16 v[80:95], v[36:39], v[220:223], v[80:95]
    ds_read_b64_tr_b16 v[32:33], v11 offset:24576
    ds_read_b64_tr_b16 v[34:35], v11 offset:25600
    s_waitcnt lgkmcnt(9)
    v_lshl_add_u32 v13, v0, 4, s14
    s_waitcnt lgkmcnt(6)
    s_barrier
    v_mfma_f32_32x32x16_bf16 v[96:111], v[16:19], v[192:195], 0
    ds_read_b64_tr_b16 v[36:37], v11 offset:26624
    ds_read_b64_tr_b16 v[38:39], v11 offset:27648
    ds_read_b128 v[224:227], v13 offset:0
    ds_read_b128 v[228:231], v13 offset:1024
    ds_read_b128 v[232:235], v13 offset:2048
    v_mfma_f32_32x32x16_bf16 v[96:111], v[20:23], v[196:199], v[96:111]
    ds_read_b64_tr_b16 v[16:17], v11 offset:28672
    ds_read_b64_tr_b16 v[18:19], v11 offset:29696
    s_waitcnt lgkmcnt(11)
    ds_read_b128 v[236:239], v13 offset:3072
    ds_read_b128 v[240:243], v13 offset:4096
    ds_read_b128 v[244:247], v13 offset:5120
    v_mfma_f32_32x32x16_bf16 v[96:111], v[24:27], v[200:203], v[96:111]
    ds_read_b64_tr_b16 v[20:21], v11 offset:30720
    ds_read_b64_tr_b16 v[22:23], v11 offset:31744
    s_waitcnt lgkmcnt(14)
    ds_read_b128 v[248:251], v13 offset:6144
    ds_read_b128 v[252:255], v13 offset:7168
    v_mfma_f32_32x32x16_bf16 v[96:111], v[28:31], v[204:207], v[96:111]
    v_subrev_u32 v11, 0x20000, v11
    ds_read_b64_tr_b16 v[24:25], v11 offset:16384
    ds_read_b64_tr_b16 v[26:27], v11 offset:17408
    s_waitcnt lgkmcnt(15)
    v_mfma_f32_32x32x16_bf16 v[96:111], v[32:35], v[208:211], v[96:111]
    ds_read_b64_tr_b16 v[28:29], v11 offset:18432
    ds_read_b64_tr_b16 v[30:31], v11 offset:19456
    s_waitcnt lgkmcnt(15)
    v_mfma_f32_32x32x16_bf16 v[96:111], v[36:39], v[212:215], v[96:111]
    ds_read_b64_tr_b16 v[32:33], v11 offset:20480
    ds_read_b64_tr_b16 v[34:35], v11 offset:21504
    s_waitcnt lgkmcnt(13)
    v_mfma_f32_32x32x16_bf16 v[96:111], v[16:19], v[216:219], v[96:111]
    ds_read_b64_tr_b16 v[36:37], v11 offset:22528
    ds_read_b64_tr_b16 v[38:39], v11 offset:23552
    s_waitcnt lgkmcnt(10)
    v_mfma_f32_32x32x16_bf16 v[96:111], v[20:23], v[220:223], v[96:111]
    ds_read_b64_tr_b16 v[16:17], v11 offset:24576
    ds_read_b64_tr_b16 v[18:19], v11 offset:25600
    s_waitcnt lgkmcnt(8)
    s_barrier
    v_mfma_f32_32x32x16_bf16 v[64:79], v[24:27], v[224:227], v[64:79]
    ds_read_b64_tr_b16 v[20:21], v11 offset:26624
    ds_read_b64_tr_b16 v[22:23], v11 offset:27648
    s_waitcnt lgkmcnt(8)
    v_mfma_f32_32x32x16_bf16 v[64:79], v[28:31], v[228:231], v[64:79]
    ds_read_b64_tr_b16 v[24:25], v11 offset:28672
    ds_read_b64_tr_b16 v[26:27], v11 offset:29696
    s_waitcnt lgkmcnt(8)
    v_mfma_f32_32x32x16_bf16 v[64:79], v[32:35], v[232:235], v[64:79]
    ds_read_b64_tr_b16 v[28:29], v11 offset:30720
    ds_read_b64_tr_b16 v[30:31], v11 offset:31744
    s_waitcnt lgkmcnt(8)
    v_mfma_f32_32x32x16_bf16 v[64:79], v[36:39], v[236:239], v[64:79]
    ds_read_b64_tr_b16 v[32:33], v11 offset:49152
    ds_read_b64_tr_b16 v[34:35], v11 offset:50176
    s_waitcnt lgkmcnt(8)
    v_mfma_f32_32x32x16_bf16 v[64:79], v[16:19], v[240:243], v[64:79]
    ds_read_b64_tr_b16 v[36:37], v11 offset:51200
    ds_read_b64_tr_b16 v[38:39], v11 offset:52224
    s_waitcnt lgkmcnt(8)
    v_mfma_f32_32x32x16_bf16 v[64:79], v[20:23], v[244:247], v[64:79]
    ds_read_b64_tr_b16 v[16:17], v11 offset:53248
    ds_read_b64_tr_b16 v[18:19], v11 offset:54272
    s_waitcnt lgkmcnt(8)
    v_mfma_f32_32x32x16_bf16 v[64:79], v[24:27], v[248:251], v[64:79]
    ds_read_b64_tr_b16 v[20:21], v11 offset:55296
    ds_read_b64_tr_b16 v[22:23], v11 offset:56320
    s_waitcnt lgkmcnt(8)
    v_mfma_f32_32x32x16_bf16 v[64:79], v[28:31], v[252:255], v[64:79]
    ds_read_b64_tr_b16 v[24:25], v11 offset:57344
    ds_read_b64_tr_b16 v[26:27], v11 offset:58368
    s_waitcnt lgkmcnt(8)
    s_barrier
    v_mfma_f32_32x32x16_bf16 v[112:127], v[32:35], v[192:195], 0
    ds_read_b64_tr_b16 v[28:29], v11 offset:59392
    ds_read_b64_tr_b16 v[30:31], v11 offset:60416
    s_waitcnt lgkmcnt(8)
    v_mfma_f32_32x32x16_bf16 v[112:127], v[36:39], v[196:199], v[112:127]
    ds_read_b64_tr_b16 v[32:33], v11 offset:61440
    ds_read_b64_tr_b16 v[34:35], v11 offset:62464
    s_waitcnt lgkmcnt(8)
    v_mfma_f32_32x32x16_bf16 v[112:127], v[16:19], v[200:203], v[112:127]
    ds_read_b64_tr_b16 v[36:37], v11 offset:63488
    ds_read_b64_tr_b16 v[38:39], v11 offset:64512
    s_waitcnt lgkmcnt(8)
    v_cvt_pk_bf16_f32 v64, v64, v65
    v_cvt_pk_bf16_f32 v65, v66, v67
    v_cvt_pk_bf16_f32 v66, v68, v69
    v_mfma_f32_32x32x16_bf16 v[112:127], v[20:23], v[204:207], v[112:127]
    v_add_u32 v11, 0x10000, v11
    ds_read_b64_tr_b16 v[16:17], v11 offset:32768
    ds_read_b64_tr_b16 v[18:19], v11 offset:33792
    s_waitcnt lgkmcnt(8)
    v_cvt_pk_bf16_f32 v67, v70, v71
    s_mov_b32 s10, 0
    buffer_store_dwordx4 v[64:67], v14, s[32:35], s10 offen offset:0 sc0 sc1
    v_mfma_f32_32x32x16_bf16 v[112:127], v[24:27], v[208:211], v[112:127]
    ds_read_b64_tr_b16 v[20:21], v11 offset:34816
    ds_read_b64_tr_b16 v[22:23], v11 offset:35840
    s_waitcnt lgkmcnt(8)
    v_mfma_f32_32x32x16_bf16 v[112:127], v[28:31], v[212:215], v[112:127]
    ds_read_b64_tr_b16 v[24:25], v11 offset:36864
    ds_read_b64_tr_b16 v[26:27], v11 offset:37888
    s_waitcnt lgkmcnt(8)
    v_mfma_f32_32x32x16_bf16 v[112:127], v[32:35], v[216:219], v[112:127]
    ds_read_b64_tr_b16 v[28:29], v11 offset:38912
    ds_read_b64_tr_b16 v[30:31], v11 offset:39936
    s_waitcnt lgkmcnt(8)
    v_mfma_f32_32x32x16_bf16 v[112:127], v[36:39], v[220:223], v[112:127]
    ds_read_b64_tr_b16 v[32:33], v11 offset:40960
    ds_read_b64_tr_b16 v[34:35], v11 offset:41984
    s_waitcnt lgkmcnt(8)
    s_barrier
    v_mfma_f32_32x32x16_bf16 v[80:95], v[16:19], v[224:227], v[80:95]
    ds_read_b64_tr_b16 v[36:37], v11 offset:43008
    ds_read_b64_tr_b16 v[38:39], v11 offset:44032
    s_waitcnt lgkmcnt(8)
    v_mfma_f32_32x32x16_bf16 v[80:95], v[20:23], v[228:231], v[80:95]
    ds_read_b64_tr_b16 v[16:17], v11 offset:45056
    ds_read_b64_tr_b16 v[18:19], v11 offset:46080
    s_waitcnt lgkmcnt(8)
    v_mfma_f32_32x32x16_bf16 v[80:95], v[24:27], v[232:235], v[80:95]
    ds_read_b64_tr_b16 v[20:21], v11 offset:47104
    ds_read_b64_tr_b16 v[22:23], v11 offset:48128
    s_waitcnt lgkmcnt(8)
    v_cvt_pk_bf16_f32 v72, v72, v73
    v_cvt_pk_bf16_f32 v73, v74, v75
    v_cvt_pk_bf16_f32 v74, v76, v77
    v_mfma_f32_32x32x16_bf16 v[80:95], v[28:31], v[236:239], v[80:95]
    ds_read_b64_tr_b16 v[24:25], v11 offset:0
    ds_read_b64_tr_b16 v[26:27], v11 offset:1024
    s_waitcnt lgkmcnt(8)
    v_cvt_pk_bf16_f32 v75, v78, v79
    s_mov_b32 s10, 0
    buffer_store_dwordx4 v[72:75], v14, s[32:35], s10 offen offset:1024 sc0 sc1
    v_mfma_f32_32x32x16_bf16 v[80:95], v[32:35], v[240:243], v[80:95]
    ds_read_b64_tr_b16 v[28:29], v11 offset:2048
    ds_read_b64_tr_b16 v[30:31], v11 offset:3072
    s_waitcnt lgkmcnt(8)
    v_mfma_f32_32x32x16_bf16 v[80:95], v[36:39], v[244:247], v[80:95]
    ds_read_b64_tr_b16 v[32:33], v11 offset:4096
    ds_read_b64_tr_b16 v[34:35], v11 offset:5120
    s_waitcnt lgkmcnt(8)
    v_mfma_f32_32x32x16_bf16 v[80:95], v[16:19], v[248:251], v[80:95]
    ds_read_b64_tr_b16 v[36:37], v11 offset:6144
    ds_read_b64_tr_b16 v[38:39], v11 offset:7168
    s_waitcnt lgkmcnt(8)
    v_mfma_f32_32x32x16_bf16 v[80:95], v[20:23], v[252:255], v[80:95]
    ds_read_b64_tr_b16 v[16:17], v11 offset:8192
    ds_read_b64_tr_b16 v[18:19], v11 offset:9216
    s_waitcnt lgkmcnt(8)
    s_barrier
    v_mfma_f32_32x32x16_bf16 v[128:143], v[24:27], v[192:195], 0
    ds_read_b64_tr_b16 v[20:21], v11 offset:10240
    ds_read_b64_tr_b16 v[22:23], v11 offset:11264
    s_waitcnt lgkmcnt(8)
    v_mfma_f32_32x32x16_bf16 v[128:143], v[28:31], v[196:199], v[128:143]
    ds_read_b64_tr_b16 v[24:25], v11 offset:12288
    ds_read_b64_tr_b16 v[26:27], v11 offset:13312
    s_waitcnt lgkmcnt(8)
    v_mfma_f32_32x32x16_bf16 v[128:143], v[32:35], v[200:203], v[128:143]
    ds_read_b64_tr_b16 v[28:29], v11 offset:14336
    ds_read_b64_tr_b16 v[30:31], v11 offset:15360
    s_waitcnt lgkmcnt(8)
    v_cvt_pk_bf16_f32 v80, v80, v81
    v_cvt_pk_bf16_f32 v81, v82, v83
    v_cvt_pk_bf16_f32 v82, v84, v85
    v_mfma_f32_32x32x16_bf16 v[128:143], v[36:39], v[204:207], v[128:143]
    v_add_u32 v11, 0x10000, v11
    ds_read_b64_tr_b16 v[32:33], v11 offset:0
    ds_read_b64_tr_b16 v[34:35], v11 offset:1024
    s_waitcnt lgkmcnt(8)
    v_cvt_pk_bf16_f32 v83, v86, v87
    s_mov_b32 s10, 8192
    buffer_store_dwordx4 v[80:83], v14, s[32:35], s10 offen offset:0 sc0 sc1
    v_mfma_f32_32x32x16_bf16 v[128:143], v[16:19], v[208:211], v[128:143]
    ds_read_b64_tr_b16 v[36:37], v11 offset:2048
    ds_read_b64_tr_b16 v[38:39], v11 offset:3072
    s_waitcnt lgkmcnt(8)
    v_mfma_f32_32x32x16_bf16 v[128:143], v[20:23], v[212:215], v[128:143]
    ds_read_b64_tr_b16 v[16:17], v11 offset:4096
    ds_read_b64_tr_b16 v[18:19], v11 offset:5120
    s_waitcnt lgkmcnt(8)
    v_mfma_f32_32x32x16_bf16 v[128:143], v[24:27], v[216:219], v[128:143]
    ds_read_b64_tr_b16 v[20:21], v11 offset:6144
    ds_read_b64_tr_b16 v[22:23], v11 offset:7168
    s_waitcnt lgkmcnt(8)
    v_mfma_f32_32x32x16_bf16 v[128:143], v[28:31], v[220:223], v[128:143]
    ds_read_b64_tr_b16 v[24:25], v11 offset:8192
    ds_read_b64_tr_b16 v[26:27], v11 offset:9216
    s_waitcnt lgkmcnt(8)
    s_barrier
    v_mfma_f32_32x32x16_bf16 v[96:111], v[32:35], v[224:227], v[96:111]
    ds_read_b64_tr_b16 v[28:29], v11 offset:10240
    ds_read_b64_tr_b16 v[30:31], v11 offset:11264
    s_waitcnt lgkmcnt(8)
    v_mfma_f32_32x32x16_bf16 v[96:111], v[36:39], v[228:231], v[96:111]
    ds_read_b64_tr_b16 v[32:33], v11 offset:12288
    ds_read_b64_tr_b16 v[34:35], v11 offset:13312
    s_waitcnt lgkmcnt(8)
    v_mfma_f32_32x32x16_bf16 v[96:111], v[16:19], v[232:235], v[96:111]
    ds_read_b64_tr_b16 v[36:37], v11 offset:14336
    ds_read_b64_tr_b16 v[38:39], v11 offset:15360
    s_waitcnt lgkmcnt(8)
    v_cvt_pk_bf16_f32 v88, v88, v89
    v_cvt_pk_bf16_f32 v89, v90, v91
    v_cvt_pk_bf16_f32 v90, v92, v93
    v_mfma_f32_32x32x16_bf16 v[96:111], v[20:23], v[236:239], v[96:111]
    v_subrev_u32 v11, 0x10000, v11
    ds_read_b64_tr_b16 v[16:17], v11 offset:49152
    ds_read_b64_tr_b16 v[18:19], v11 offset:50176
    s_waitcnt lgkmcnt(8)
    v_cvt_pk_bf16_f32 v91, v94, v95
    s_mov_b32 s10, 8192
    buffer_store_dwordx4 v[88:91], v14, s[32:35], s10 offen offset:1024 sc0 sc1
    v_mfma_f32_32x32x16_bf16 v[96:111], v[24:27], v[240:243], v[96:111]
    ds_read_b64_tr_b16 v[20:21], v11 offset:51200
    ds_read_b64_tr_b16 v[22:23], v11 offset:52224
    s_waitcnt lgkmcnt(8)
    v_mfma_f32_32x32x16_bf16 v[96:111], v[28:31], v[244:247], v[96:111]
    ds_read_b64_tr_b16 v[24:25], v11 offset:53248
    ds_read_b64_tr_b16 v[26:27], v11 offset:54272
    s_waitcnt lgkmcnt(8)
    v_mfma_f32_32x32x16_bf16 v[96:111], v[32:35], v[248:251], v[96:111]
    ds_read_b64_tr_b16 v[28:29], v11 offset:55296
    ds_read_b64_tr_b16 v[30:31], v11 offset:56320
    s_waitcnt lgkmcnt(8)
    v_mfma_f32_32x32x16_bf16 v[96:111], v[36:39], v[252:255], v[96:111]
    ds_read_b64_tr_b16 v[32:33], v11 offset:57344
    ds_read_b64_tr_b16 v[34:35], v11 offset:58368
    s_waitcnt lgkmcnt(8)
    s_barrier
    v_mfma_f32_32x32x16_bf16 v[144:159], v[16:19], v[192:195], 0
    ds_read_b64_tr_b16 v[36:37], v11 offset:59392
    ds_read_b64_tr_b16 v[38:39], v11 offset:60416
    s_waitcnt lgkmcnt(8)
    v_mfma_f32_32x32x16_bf16 v[144:159], v[20:23], v[196:199], v[144:159]
    ds_read_b64_tr_b16 v[16:17], v11 offset:61440
    ds_read_b64_tr_b16 v[18:19], v11 offset:62464
    s_waitcnt lgkmcnt(8)
    v_mfma_f32_32x32x16_bf16 v[144:159], v[24:27], v[200:203], v[144:159]
    ds_read_b64_tr_b16 v[20:21], v11 offset:63488
    ds_read_b64_tr_b16 v[22:23], v11 offset:64512
    s_waitcnt lgkmcnt(8)
    v_cvt_pk_bf16_f32 v96, v96, v97
    v_cvt_pk_bf16_f32 v97, v98, v99
    v_cvt_pk_bf16_f32 v98, v100, v101
    v_mfma_f32_32x32x16_bf16 v[144:159], v[28:31], v[204:207], v[144:159]
    v_subrev_u32 v11, 0x10000, v11
    ds_read_b64_tr_b16 v[24:25], v11 offset:0
    ds_read_b64_tr_b16 v[26:27], v11 offset:1024
    s_waitcnt lgkmcnt(8)
    v_cvt_pk_bf16_f32 v99, v102, v103
    s_mov_b32 s10, 16384
    buffer_store_dwordx4 v[96:99], v14, s[32:35], s10 offen offset:0 sc0 sc1
    v_mfma_f32_32x32x16_bf16 v[144:159], v[32:35], v[208:211], v[144:159]
    ds_read_b64_tr_b16 v[28:29], v11 offset:2048
    ds_read_b64_tr_b16 v[30:31], v11 offset:3072
    s_waitcnt lgkmcnt(8)
    v_mfma_f32_32x32x16_bf16 v[144:159], v[36:39], v[212:215], v[144:159]
    ds_read_b64_tr_b16 v[32:33], v11 offset:4096
    ds_read_b64_tr_b16 v[34:35], v11 offset:5120
    s_waitcnt lgkmcnt(8)
    v_mfma_f32_32x32x16_bf16 v[144:159], v[16:19], v[216:219], v[144:159]
    ds_read_b64_tr_b16 v[36:37], v11 offset:6144
    ds_read_b64_tr_b16 v[38:39], v11 offset:7168
    s_waitcnt lgkmcnt(8)
    v_mfma_f32_32x32x16_bf16 v[144:159], v[20:23], v[220:223], v[144:159]
    ds_read_b64_tr_b16 v[16:17], v11 offset:8192
    ds_read_b64_tr_b16 v[18:19], v11 offset:9216
    s_waitcnt lgkmcnt(8)
    s_barrier
    v_mfma_f32_32x32x16_bf16 v[112:127], v[24:27], v[224:227], v[112:127]
    ds_read_b64_tr_b16 v[20:21], v11 offset:10240
    ds_read_b64_tr_b16 v[22:23], v11 offset:11264
    s_waitcnt lgkmcnt(8)
    v_mfma_f32_32x32x16_bf16 v[112:127], v[28:31], v[228:231], v[112:127]
    ds_read_b64_tr_b16 v[24:25], v11 offset:12288
    ds_read_b64_tr_b16 v[26:27], v11 offset:13312
    s_waitcnt lgkmcnt(8)
    v_mfma_f32_32x32x16_bf16 v[112:127], v[32:35], v[232:235], v[112:127]
    ds_read_b64_tr_b16 v[28:29], v11 offset:14336
    ds_read_b64_tr_b16 v[30:31], v11 offset:15360
    s_waitcnt lgkmcnt(8)
    v_cvt_pk_bf16_f32 v104, v104, v105
    v_cvt_pk_bf16_f32 v105, v106, v107
    v_cvt_pk_bf16_f32 v106, v108, v109
    v_mfma_f32_32x32x16_bf16 v[112:127], v[36:39], v[236:239], v[112:127]
    ds_read_b64_tr_b16 v[32:33], v11 offset:32768
    ds_read_b64_tr_b16 v[34:35], v11 offset:33792
    s_waitcnt lgkmcnt(8)
    v_cvt_pk_bf16_f32 v107, v110, v111
    s_mov_b32 s10, 16384
    buffer_store_dwordx4 v[104:107], v14, s[32:35], s10 offen offset:1024 sc0 sc1
    v_mfma_f32_32x32x16_bf16 v[112:127], v[16:19], v[240:243], v[112:127]
    ds_read_b64_tr_b16 v[36:37], v11 offset:34816
    ds_read_b64_tr_b16 v[38:39], v11 offset:35840
    s_waitcnt lgkmcnt(8)
    v_mfma_f32_32x32x16_bf16 v[112:127], v[20:23], v[244:247], v[112:127]
    ds_read_b64_tr_b16 v[16:17], v11 offset:36864
    ds_read_b64_tr_b16 v[18:19], v11 offset:37888
    s_waitcnt lgkmcnt(8)
    v_mfma_f32_32x32x16_bf16 v[112:127], v[24:27], v[248:251], v[112:127]
    ds_read_b64_tr_b16 v[20:21], v11 offset:38912
    ds_read_b64_tr_b16 v[22:23], v11 offset:39936
    s_waitcnt lgkmcnt(8)
    v_mfma_f32_32x32x16_bf16 v[112:127], v[28:31], v[252:255], v[112:127]
    ds_read_b64_tr_b16 v[24:25], v11 offset:40960
    ds_read_b64_tr_b16 v[26:27], v11 offset:41984
    s_waitcnt lgkmcnt(8)
    s_barrier
    v_mfma_f32_32x32x16_bf16 v[160:175], v[32:35], v[192:195], 0
    ds_read_b64_tr_b16 v[28:29], v11 offset:43008
    ds_read_b64_tr_b16 v[30:31], v11 offset:44032
    s_waitcnt lgkmcnt(8)
    v_mfma_f32_32x32x16_bf16 v[160:175], v[36:39], v[196:199], v[160:175]
    ds_read_b64_tr_b16 v[32:33], v11 offset:45056
    ds_read_b64_tr_b16 v[34:35], v11 offset:46080
    s_waitcnt lgkmcnt(8)
    v_mfma_f32_32x32x16_bf16 v[160:175], v[16:19], v[200:203], v[160:175]
    ds_read_b64_tr_b16 v[36:37], v11 offset:47104
    ds_read_b64_tr_b16 v[38:39], v11 offset:48128
    s_waitcnt lgkmcnt(8)
    v_cvt_pk_bf16_f32 v112, v112, v113
    v_cvt_pk_bf16_f32 v113, v114, v115
    v_cvt_pk_bf16_f32 v114, v116, v117
    v_mfma_f32_32x32x16_bf16 v[160:175], v[20:23], v[204:207], v[160:175]
    v_add_u32 v11, 0x20000, v11
    ds_read_b64_tr_b16 v[16:17], v11 offset:16384
    ds_read_b64_tr_b16 v[18:19], v11 offset:17408
    s_waitcnt lgkmcnt(8)
    v_cvt_pk_bf16_f32 v115, v118, v119
    s_mov_b32 s10, 24576
    buffer_store_dwordx4 v[112:115], v14, s[32:35], s10 offen offset:0 sc0 sc1
    v_mfma_f32_32x32x16_bf16 v[160:175], v[24:27], v[208:211], v[160:175]
    ds_read_b64_tr_b16 v[20:21], v11 offset:18432
    ds_read_b64_tr_b16 v[22:23], v11 offset:19456
    s_waitcnt lgkmcnt(8)
    v_mfma_f32_32x32x16_bf16 v[160:175], v[28:31], v[212:215], v[160:175]
    ds_read_b64_tr_b16 v[24:25], v11 offset:20480
    ds_read_b64_tr_b16 v[26:27], v11 offset:21504
    s_waitcnt lgkmcnt(8)
    v_mfma_f32_32x32x16_bf16 v[160:175], v[32:35], v[216:219], v[160:175]
    ds_read_b64_tr_b16 v[28:29], v11 offset:22528
    ds_read_b64_tr_b16 v[30:31], v11 offset:23552
    s_waitcnt lgkmcnt(8)
    v_mfma_f32_32x32x16_bf16 v[160:175], v[36:39], v[220:223], v[160:175]
    ds_read_b64_tr_b16 v[32:33], v11 offset:24576
    ds_read_b64_tr_b16 v[34:35], v11 offset:25600
    s_waitcnt lgkmcnt(8)
    s_barrier
    v_mfma_f32_32x32x16_bf16 v[128:143], v[16:19], v[224:227], v[128:143]
    ds_read_b64_tr_b16 v[36:37], v11 offset:26624
    ds_read_b64_tr_b16 v[38:39], v11 offset:27648
    s_waitcnt lgkmcnt(8)
    v_mfma_f32_32x32x16_bf16 v[128:143], v[20:23], v[228:231], v[128:143]
    ds_read_b64_tr_b16 v[16:17], v11 offset:28672
    ds_read_b64_tr_b16 v[18:19], v11 offset:29696
    s_waitcnt lgkmcnt(8)
    v_mfma_f32_32x32x16_bf16 v[128:143], v[24:27], v[232:235], v[128:143]
    ds_read_b64_tr_b16 v[20:21], v11 offset:30720
    ds_read_b64_tr_b16 v[22:23], v11 offset:31744
    s_waitcnt lgkmcnt(8)
    v_cvt_pk_bf16_f32 v120, v120, v121
    v_cvt_pk_bf16_f32 v121, v122, v123
    v_cvt_pk_bf16_f32 v122, v124, v125
    v_mfma_f32_32x32x16_bf16 v[128:143], v[28:31], v[236:239], v[128:143]
    v_subrev_u32 v11, 0x10000, v11
    ds_read_b64_tr_b16 v[24:25], v11 offset:16384
    ds_read_b64_tr_b16 v[26:27], v11 offset:17408
    s_waitcnt lgkmcnt(8)
    v_cvt_pk_bf16_f32 v123, v126, v127
    s_mov_b32 s10, 24576
    buffer_store_dwordx4 v[120:123], v14, s[32:35], s10 offen offset:1024 sc0 sc1
    v_mfma_f32_32x32x16_bf16 v[128:143], v[32:35], v[240:243], v[128:143]
    ds_read_b64_tr_b16 v[28:29], v11 offset:18432
    ds_read_b64_tr_b16 v[30:31], v11 offset:19456
    s_waitcnt lgkmcnt(8)
    v_mfma_f32_32x32x16_bf16 v[128:143], v[36:39], v[244:247], v[128:143]
    ds_read_b64_tr_b16 v[32:33], v11 offset:20480
    ds_read_b64_tr_b16 v[34:35], v11 offset:21504
    s_waitcnt lgkmcnt(8)
    v_mfma_f32_32x32x16_bf16 v[128:143], v[16:19], v[248:251], v[128:143]
    ds_read_b64_tr_b16 v[36:37], v11 offset:22528
    ds_read_b64_tr_b16 v[38:39], v11 offset:23552
    s_waitcnt lgkmcnt(8)
    v_mfma_f32_32x32x16_bf16 v[128:143], v[20:23], v[252:255], v[128:143]
    ds_read_b64_tr_b16 v[16:17], v11 offset:24576
    ds_read_b64_tr_b16 v[18:19], v11 offset:25600
    s_waitcnt lgkmcnt(8)
    s_barrier
    v_mfma_f32_32x32x16_bf16 v[144:159], v[24:27], v[224:227], v[144:159]
    ds_read_b64_tr_b16 v[20:21], v11 offset:26624
    ds_read_b64_tr_b16 v[22:23], v11 offset:27648
    s_waitcnt lgkmcnt(8)
    v_mfma_f32_32x32x16_bf16 v[144:159], v[28:31], v[228:231], v[144:159]
    ds_read_b64_tr_b16 v[24:25], v11 offset:28672
    ds_read_b64_tr_b16 v[26:27], v11 offset:29696
    s_waitcnt lgkmcnt(8)
    v_mfma_f32_32x32x16_bf16 v[144:159], v[32:35], v[232:235], v[144:159]
    ds_read_b64_tr_b16 v[28:29], v11 offset:30720
    ds_read_b64_tr_b16 v[30:31], v11 offset:31744
    s_waitcnt lgkmcnt(8)
    v_cvt_pk_bf16_f32 v128, v128, v129
    v_cvt_pk_bf16_f32 v129, v130, v131
    v_cvt_pk_bf16_f32 v130, v132, v133
    v_mfma_f32_32x32x16_bf16 v[144:159], v[36:39], v[236:239], v[144:159]
    v_subrev_u32 v11, 0x10000, v11
    ds_read_b64_tr_b16 v[32:33], v11 offset:16384
    ds_read_b64_tr_b16 v[34:35], v11 offset:17408
    s_waitcnt lgkmcnt(8)
    v_cvt_pk_bf16_f32 v131, v134, v135
    s_mov_b32 s10, 32768
    buffer_store_dwordx4 v[128:131], v14, s[32:35], s10 offen offset:0 sc0 sc1
    v_mfma_f32_32x32x16_bf16 v[144:159], v[16:19], v[240:243], v[144:159]
    ds_read_b64_tr_b16 v[36:37], v11 offset:18432
    ds_read_b64_tr_b16 v[38:39], v11 offset:19456
    s_waitcnt lgkmcnt(8)
    v_mfma_f32_32x32x16_bf16 v[144:159], v[20:23], v[244:247], v[144:159]
    ds_read_b64_tr_b16 v[16:17], v11 offset:20480
    ds_read_b64_tr_b16 v[18:19], v11 offset:21504
    s_waitcnt lgkmcnt(8)
    v_cvt_pk_bf16_f32 v136, v136, v137
    v_cvt_pk_bf16_f32 v137, v138, v139
    v_cvt_pk_bf16_f32 v138, v140, v141
    v_mfma_f32_32x32x16_bf16 v[144:159], v[24:27], v[248:251], v[144:159]
    ds_read_b64_tr_b16 v[20:21], v11 offset:22528
    ds_read_b64_tr_b16 v[22:23], v11 offset:23552
    s_waitcnt lgkmcnt(8)
    v_cvt_pk_bf16_f32 v139, v142, v143
    s_mov_b32 s10, 32768
    buffer_store_dwordx4 v[136:139], v14, s[32:35], s10 offen offset:1024 sc0 sc1
    v_mfma_f32_32x32x16_bf16 v[144:159], v[28:31], v[252:255], v[144:159]
    ds_read_b64_tr_b16 v[24:25], v11 offset:24576
    ds_read_b64_tr_b16 v[26:27], v11 offset:25600
    s_waitcnt lgkmcnt(8)
    s_barrier
    v_mfma_f32_32x32x16_bf16 v[160:175], v[32:35], v[224:227], v[160:175]
    ds_read_b64_tr_b16 v[28:29], v11 offset:26624
    ds_read_b64_tr_b16 v[30:31], v11 offset:27648
    s_waitcnt lgkmcnt(8)
    v_mfma_f32_32x32x16_bf16 v[160:175], v[36:39], v[228:231], v[160:175]
    ds_read_b64_tr_b16 v[32:33], v11 offset:28672
    ds_read_b64_tr_b16 v[34:35], v11 offset:29696
    s_waitcnt lgkmcnt(8)
    v_mfma_f32_32x32x16_bf16 v[160:175], v[16:19], v[232:235], v[160:175]
    ds_read_b64_tr_b16 v[36:37], v11 offset:30720
    ds_read_b64_tr_b16 v[38:39], v11 offset:31744
    s_waitcnt lgkmcnt(8)
    v_cvt_pk_bf16_f32 v144, v144, v145
    v_cvt_pk_bf16_f32 v145, v146, v147
    v_cvt_pk_bf16_f32 v146, v148, v149
    v_mfma_f32_32x32x16_bf16 v[160:175], v[20:23], v[236:239], v[160:175]
    s_waitcnt lgkmcnt(6)
    v_cvt_pk_bf16_f32 v147, v150, v151
    s_mov_b32 s10, 40960
    buffer_store_dwordx4 v[144:147], v14, s[32:35], s10 offen offset:0 sc0 sc1
    v_mfma_f32_32x32x16_bf16 v[160:175], v[24:27], v[240:243], v[160:175]
    s_waitcnt lgkmcnt(4)
    v_mfma_f32_32x32x16_bf16 v[160:175], v[28:31], v[244:247], v[160:175]
    s_waitcnt lgkmcnt(2)
    v_cvt_pk_bf16_f32 v152, v152, v153
    v_cvt_pk_bf16_f32 v153, v154, v155
    v_cvt_pk_bf16_f32 v154, v156, v157
    v_mfma_f32_32x32x16_bf16 v[160:175], v[32:35], v[248:251], v[160:175]
    s_waitcnt lgkmcnt(0)
    v_cvt_pk_bf16_f32 v155, v158, v159
    s_mov_b32 s10, 40960
    buffer_store_dwordx4 v[152:155], v14, s[32:35], s10 offen offset:1024 sc0 sc1
    v_mfma_f32_32x32x16_bf16 v[160:175], v[36:39], v[252:255], v[160:175]
    s_nop 11
    v_cvt_pk_bf16_f32 v160, v160, v161
    v_cvt_pk_bf16_f32 v161, v162, v163
    v_cvt_pk_bf16_f32 v162, v164, v165
    v_cvt_pk_bf16_f32 v163, v166, v167
    s_mov_b32 s10, 49152
    buffer_store_dwordx4 v[160:163], v14, s[32:35], s10 offen offset:0 sc0 sc1
    v_cvt_pk_bf16_f32 v168, v168, v169
    v_cvt_pk_bf16_f32 v169, v170, v171
    v_cvt_pk_bf16_f32 v170, v172, v173
    v_cvt_pk_bf16_f32 v171, v174, v175
    s_mov_b32 s10, 49152
    buffer_store_dwordx4 v[168:171], v14, s[32:35], s10 offen offset:1024 sc0 sc1
    s_endpgm
L1_load:
    s_and_b32 s8, s3, 3
    s_and_b32 s9, s3, 1
    v_lshrrev_b32 v8, 3, v0
    v_and_b32 v9, 7, v0
    v_lshrrev_b32 v10, 4, v0
    s_lshl_b32 s10, s9, 2
    v_add_u32 v10, s10, v10
    v_xor_b32 v10, v10, v9
    v_mul_u32_u24 v11, 896, v8
    s_mul_i32 s10, s8, 7168
    v_add_u32 v11, s10, v11
    v_lshl_add_u32 v1, v10, 4, v11
    s_mul_i32 s10, s5, 57344
    s_lshl_b32 s15, s8, 10
    s_waitcnt lgkmcnt(0)
    s_add_u32 s32, s16, s10
    s_addc_u32 s33, s17, 0
    s_and_b32 s33, s33, 0xffff
    s_mov_b32 s34, 57344
    s_mov_b32 s35, 0x20000
    s_add_u32 m0, s15, 0
    s_mov_b32 s10, 0
    buffer_load_dwordx4 v1, s[32:35], s10 offen lds
    s_add_u32 m0, s15, 4096
    s_mov_b32 s10, 28672
    buffer_load_dwordx4 v1, s[32:35], s10 offen lds
    s_add_u32 m0, s15, 8192
    s_mov_b32 s10, 128
    buffer_load_dwordx4 v1, s[32:35], s10 offen lds
    s_add_u32 m0, s15, 12288
    s_mov_b32 s10, 28800
    buffer_load_dwordx4 v1, s[32:35], s10 offen lds
    v_bfe_u32 v10, v0, 4, 1
    v_lshlrev_b32 v10, 2, v10
    v_xor_b32 v10, v10, v9
    v_lshl_add_u32 v5, v10, 4, v11
    v_lshrrev_b32 v8, 5, v0
    v_and_b32 v9, 31, v0
    s_lshl_b32 s10, s8, 1
    v_add_u32 v11, s10, v8
    v_and_b32 v10, 3, v11
    v_lshlrev_b32 v10, 2, v10
    v_xor_b32 v10, v10, v9
    v_lshlrev_b32 v12, 13, v11
    v_lshl_add_u32 v2, v10, 4, v12
    v_lshrrev_b32 v8, 4, v0
    v_and_b32 v9, 15, v0
    s_lshl_b32 s10, s8, 2
    v_add_u32 v10, s10, v8
    v_lshlrev_b32 v11, 9, v10
    v_xor_b32 v10, v10, v9
    v_lshl_add_u32 v3, v10, 4, v11
    v_lshlrev_b32 v10, 2, v8
    v_xor_b32 v10, v10, v9
    v_lshl_add_u32 v4, v10, 4, v11
    s_lshl_b32 s11, s6, 9
    s_mul_i32 s12, s6, 229376
    s_lshl_b32 s13, s5, 3
    s_add_u32 s13, s13, s4
    s_lshl_b32 s13, s13, 18
    s_add_u32 s36, s22, s11
    s_addc_u32 s37, s23, 0
    s_and_b32 s37, s37, 0xffff
    s_sub_u32 s38, 3670016, s11
    s_mov_b32 s39, 0x20000
    s_add_u32 s40, s24, s12
    s_addc_u32 s41, s25, 0
    s_and_b32 s41, s41, 0xffff
    s_mov_b32 s42, 229376
    s_mov_b32 s43, 0x20000
    s_add_u32 s44, s18, s13
    s_addc_u32 s45, s19, 0
    s_and_b32 s45, s45, 0xffff
    s_mov_b32 s46, 262144
    s_mov_b32 s47, 0x20000
    s_add_u32 s48, s20, s13
    s_addc_u32 s49, s21, 0
    s_and_b32 s49, s49, 0xffff
    s_mov_b32 s50, 262144
    s_mov_b32 s51, 0x20000
    s_lshl_b32 s14, s7, 15
    s_add_u32 m0, s15, 16384
    s_mov_b32 s10, 0
    buffer_load_dwordx4 v2, s[36:39], s10 offen lds
    s_add_u32 m0, s15, 20480
    s_mov_b32 s10, 65536
    buffer_load_dwordx4 v2, s[36:39], s10 offen lds
    s_add_u32 m0, s15, 24576
    s_mov_b32 s10, 131072
    buffer_load_dwordx4 v2, s[36:39], s10 offen lds
    s_add_u32 m0, s15, 28672
    s_mov_b32 s10, 196608
    buffer_load_dwordx4 v2, s[36:39], s10 offen lds
    s_add_u32 m0, s15, 32768
    s_mov_b32 s10, 262144
    buffer_load_dwordx4 v2, s[36:39], s10 offen lds
    s_add_u32 m0, s15, 36864
    s_mov_b32 s10, 327680
    buffer_load_dwordx4 v2, s[36:39], s10 offen lds
    s_add_u32 m0, s15, 40960
    s_mov_b32 s10, 393216
    buffer_load_dwordx4 v2, s[36:39], s10 offen lds
    s_add_u32 m0, s15, 45056
    s_mov_b32 s10, 458752
    buffer_load_dwordx4 v2, s[36:39], s10 offen lds
    s_add_u32 m0, s15, 49152
    s_mov_b32 s10, 524288
    buffer_load_dwordx4 v2, s[36:39], s10 offen lds
    s_add_u32 m0, s15, 53248
    s_mov_b32 s10, 589824
    buffer_load_dwordx4 v2, s[36:39], s10 offen lds
    s_add_u32 m0, s15, 57344
    s_mov_b32 s10, 655360
    buffer_load_dwordx4 v2, s[36:39], s10 offen lds
    s_add_u32 m0, s15, 61440
    s_mov_b32 s10, 720896
    buffer_load_dwordx4 v2, s[36:39], s10 offen lds
    s_add_u32 m0, s15, 65536
    s_mov_b32 s10, 786432
    buffer_load_dwordx4 v2, s[36:39], s10 offen lds
    s_add_u32 m0, s15, 69632
    s_mov_b32 s10, 851968
    buffer_load_dwordx4 v2, s[36:39], s10 offen lds
    s_add_u32 m0, s15, 73728
    s_mov_b32 s10, 917504
    buffer_load_dwordx4 v2, s[36:39], s10 offen lds
    s_add_u32 m0, s15, 77824
    s_mov_b32 s10, 983040
    buffer_load_dwordx4 v2, s[36:39], s10 offen lds
    s_add_u32 m0, s15, 81920
    s_mov_b32 s10, 256
    buffer_load_dwordx4 v1, s[32:35], s10 offen lds
    s_add_u32 m0, s15, 86016
    s_mov_b32 s10, 28928
    buffer_load_dwordx4 v1, s[32:35], s10 offen lds
    s_add_u32 m0, s15, 90112
    s_mov_b32 s10, 384
    buffer_load_dwordx4 v1, s[32:35], s10 offen lds
    s_add_u32 m0, s15, 94208
    s_mov_b32 s10, 29056
    buffer_load_dwordx4 v1, s[32:35], s10 offen lds
    s_add_u32 m0, s15, 98304
    s_mov_b32 s10, 1048576
    buffer_load_dwordx4 v2, s[36:39], s10 offen lds
    s_add_u32 m0, s15, 102400
    s_mov_b32 s10, 1114112
    buffer_load_dwordx4 v2, s[36:39], s10 offen lds
    s_add_u32 m0, s15, 106496
    s_mov_b32 s10, 1179648
    buffer_load_dwordx4 v2, s[36:39], s10 offen lds
    s_add_u32 m0, s15, 110592
    s_mov_b32 s10, 1245184
    buffer_load_dwordx4 v2, s[36:39], s10 offen lds
    s_waitcnt vmcnt(24)
    s_waitcnt vmcnt(20)
    s_waitcnt vmcnt(16)
    s_barrier
    s_add_u32 m0, s15, 114688
    s_mov_b32 s10, 1310720
    buffer_load_dwordx4 v2, s[36:39], s10 offen lds
    s_add_u32 m0, s15, 118784
    s_mov_b32 s10, 1376256
    buffer_load_dwordx4 v2, s[36:39], s10 offen lds
    s_add_u32 m0, s15, 122880
    s_mov_b32 s10, 1441792
    buffer_load_dwordx4 v2, s[36:39], s10 offen lds
    s_add_u32 m0, s15, 126976
    s_mov_b32 s10, 1507328
    buffer_load_dwordx4 v2, s[36:39], s10 offen lds
    s_waitcnt vmcnt(16)
    s_barrier
    s_add_u32 m0, s15, 131072
    s_mov_b32 s10, 1572864
    buffer_load_dwordx4 v2, s[36:39], s10 offen lds
    s_add_u32 m0, s15, 135168
    s_mov_b32 s10, 1638400
    buffer_load_dwordx4 v2, s[36:39], s10 offen lds
    s_add_u32 m0, s15, 139264
    s_mov_b32 s10, 1703936
    buffer_load_dwordx4 v2, s[36:39], s10 offen lds
    s_add_u32 m0, s15, 143360
    s_mov_b32 s10, 1769472
    buffer_load_dwordx4 v2, s[36:39], s10 offen lds
    s_waitcnt vmcnt(16)
    s_barrier
    s_add_u32 m0, s15, 147456
    s_mov_b32 s10, 1835008
    buffer_load_dwordx4 v2, s[36:39], s10 offen lds
    s_add_u32 m0, s15, 151552
    s_mov_b32 s10, 1900544
    buffer_load_dwordx4 v2, s[36:39], s10 offen lds
    s_add_u32 m0, s15, 155648
    s_mov_b32 s10, 1966080
    buffer_load_dwordx4 v2, s[36:39], s10 offen lds
    s_add_u32 m0, s15, 159744
    s_mov_b32 s10, 2031616
    buffer_load_dwordx4 v2, s[36:39], s10 offen lds
    s_waitcnt vmcnt(16)
    s_waitcnt vmcnt(12)
    s_barrier
    s_add_u32 m0, s15, 0
    s_mov_b32 s10, 512
    buffer_load_dwordx4 v1, s[32:35], s10 offen lds
    s_add_u32 m0, s15, 4096
    s_mov_b32 s10, 29184
    buffer_load_dwordx4 v1, s[32:35], s10 offen lds
    s_add_u32 m0, s15, 8192
    s_mov_b32 s10, 640
    buffer_load_dwordx4 v1, s[32:35], s10 offen lds
    s_add_u32 m0, s15, 12288
    s_mov_b32 s10, 29312
    buffer_load_dwordx4 v1, s[32:35], s10 offen lds
    s_add_u32 m0, s15, 16384
    s_mov_b32 s10, 2097152
    buffer_load_dwordx4 v2, s[36:39], s10 offen lds
    s_add_u32 m0, s15, 20480
    s_mov_b32 s10, 2162688
    buffer_load_dwordx4 v2, s[36:39], s10 offen lds
    s_add_u32 m0, s15, 24576
    s_mov_b32 s10, 2228224
    buffer_load_dwordx4 v2, s[36:39], s10 offen lds
    s_add_u32 m0, s15, 28672
    s_mov_b32 s10, 2293760
    buffer_load_dwordx4 v2, s[36:39], s10 offen lds
    s_waitcnt vmcnt(16)
    s_barrier
    s_add_u32 m0, s15, 32768
    s_mov_b32 s10, 2359296
    buffer_load_dwordx4 v2, s[36:39], s10 offen lds
    s_add_u32 m0, s15, 36864
    s_mov_b32 s10, 2424832
    buffer_load_dwordx4 v2, s[36:39], s10 offen lds
    s_add_u32 m0, s15, 40960
    s_mov_b32 s10, 2490368
    buffer_load_dwordx4 v2, s[36:39], s10 offen lds
    s_add_u32 m0, s15, 45056
    s_mov_b32 s10, 2555904
    buffer_load_dwordx4 v2, s[36:39], s10 offen lds
    s_waitcnt vmcnt(16)
    s_barrier
    s_add_u32 m0, s15, 49152
    s_mov_b32 s10, 2621440
    buffer_load_dwordx4 v2, s[36:39], s10 offen lds
    s_add_u32 m0, s15, 53248
    s_mov_b32 s10, 2686976
    buffer_load_dwordx4 v2, s[36:39], s10 offen lds
    s_add_u32 m0, s15, 57344
    s_mov_b32 s10, 2752512
    buffer_load_dwordx4 v2, s[36:39], s10 offen lds
    s_add_u32 m0, s15, 61440
    s_mov_b32 s10, 2818048
    buffer_load_dwordx4 v2, s[36:39], s10 offen lds
    s_waitcnt vmcnt(16)
    s_barrier
    s_add_u32 m0, s15, 65536
    s_mov_b32 s10, 2883584
    buffer_load_dwordx4 v2, s[36:39], s10 offen lds
    s_add_u32 m0, s15, 69632
    s_mov_b32 s10, 2949120
    buffer_load_dwordx4 v2, s[36:39], s10 offen lds
    s_add_u32 m0, s15, 73728
    s_mov_b32 s10, 3014656
    buffer_load_dwordx4 v2, s[36:39], s10 offen lds
    s_add_u32 m0, s15, 77824
    s_mov_b32 s10, 3080192
    buffer_load_dwordx4 v2, s[36:39], s10 offen lds
    s_waitcnt vmcnt(16)
    s_waitcnt vmcnt(12)
    s_barrier
    s_add_u32 m0, s15, 81920
    s_mov_b32 s10, 768
    buffer_load_dwordx4 v1, s[32:35], s10 offen lds
    s_add_u32 m0, s15, 86016
    s_mov_b32 s10, 29440
    buffer_load_dwordx4 v1, s[32:35], s10 offen lds
    s_add_u32 m0, s15, 98304
    s_mov_b32 s10, 3145728
    buffer_load_dwordx4 v2, s[36:39], s10 offen lds
    s_add_u32 m0, s15, 102400
    s_mov_b32 s10, 3211264
    buffer_load_dwordx4 v2, s[36:39], s10 offen lds
    s_add_u32 m0, s15, 106496
    s_mov_b32 s10, 3276800
    buffer_load_dwordx4 v2, s[36:39], s10 offen lds
    s_add_u32 m0, s15, 110592
    s_mov_b32 s10, 3342336
    buffer_load_dwordx4 v2, s[36:39], s10 offen lds
    s_add_u32 m0, s15, 114688
    s_mov_b32 s10, 3407872
    buffer_load_dwordx4 v2, s[36:39], s10 offen lds
    s_add_u32 m0, s15, 118784
    s_mov_b32 s10, 3473408
    buffer_load_dwordx4 v2, s[36:39], s10 offen lds
    s_add_u32 m0, s15, 122880
    s_mov_b32 s10, 3538944
    buffer_load_dwordx4 v2, s[36:39], s10 offen lds
    s_add_u32 m0, s15, 126976
    s_mov_b32 s10, 3604480
    buffer_load_dwordx4 v2, s[36:39], s10 offen lds
    s_waitcnt vmcnt(18)
    s_barrier
    s_waitcnt vmcnt(14)
    s_barrier
    s_add_u32 m0, s15, 131072
    s_mov_b32 s10, 0
    buffer_load_dwordx4 v3, s[44:47], s10 offen nt lds
    s_add_u32 m0, s15, 135168
    s_mov_b32 s10, 8192
    buffer_load_dwordx4 v3, s[44:47], s10 offen nt lds
    s_add_u32 m0, s15, 139264
    s_mov_b32 s10, 16384
    buffer_load_dwordx4 v3, s[44:47], s10 offen nt lds
    s_add_u32 m0, s15, 143360
    s_mov_b32 s10, 24576
    buffer_load_dwordx4 v3, s[44:47], s10 offen nt lds
    s_waitcnt vmcnt(14)
    s_barrier
    s_add_u32 m0, s15, 147456
    s_mov_b32 s10, 256
    buffer_load_dwordx4 v3, s[44:47], s10 offen nt lds
    s_add_u32 m0, s15, 151552
    s_mov_b32 s10, 8448
    buffer_load_dwordx4 v3, s[44:47], s10 offen nt lds
    s_add_u32 m0, s15, 155648
    s_mov_b32 s10, 16640
    buffer_load_dwordx4 v3, s[44:47], s10 offen nt lds
    s_add_u32 m0, s15, 159744
    s_mov_b32 s10, 24832
    buffer_load_dwordx4 v3, s[44:47], s10 offen nt lds
    s_waitcnt vmcnt(16)
    s_waitcnt vmcnt(12)
    s_waitcnt vmcnt(8)
    s_barrier
    s_add_u32 m0, s15, 0
    s_mov_b32 s10, 32768
    buffer_load_dwordx4 v3, s[44:47], s10 offen nt lds
    s_add_u32 m0, s15, 4096
    s_mov_b32 s10, 40960
    buffer_load_dwordx4 v3, s[44:47], s10 offen nt lds
    s_add_u32 m0, s15, 8192
    s_mov_b32 s10, 49152
    buffer_load_dwordx4 v3, s[44:47], s10 offen nt lds
    s_add_u32 m0, s15, 12288
    s_mov_b32 s10, 57344
    buffer_load_dwordx4 v3, s[44:47], s10 offen nt lds
    s_barrier
    s_add_u32 m0, s15, 49152
    s_mov_b32 s10, 33024
    buffer_load_dwordx4 v3, s[44:47], s10 offen nt lds
    s_add_u32 m0, s15, 53248
    s_mov_b32 s10, 41216
    buffer_load_dwordx4 v3, s[44:47], s10 offen nt lds
    s_add_u32 m0, s15, 57344
    s_mov_b32 s10, 49408
    buffer_load_dwordx4 v3, s[44:47], s10 offen nt lds
    s_add_u32 m0, s15, 61440
    s_mov_b32 s10, 57600
    buffer_load_dwordx4 v3, s[44:47], s10 offen nt lds
    s_waitcnt vmcnt(12)
    s_barrier
    s_add_u32 m0, s15, 65536
    s_mov_b32 s10, 65536
    buffer_load_dwordx4 v3, s[44:47], s10 offen nt lds
    s_add_u32 m0, s15, 69632
    s_mov_b32 s10, 73728
    buffer_load_dwordx4 v3, s[44:47], s10 offen nt lds
    s_add_u32 m0, s15, 73728
    s_mov_b32 s10, 81920
    buffer_load_dwordx4 v3, s[44:47], s10 offen nt lds
    s_add_u32 m0, s15, 77824
    s_mov_b32 s10, 90112
    buffer_load_dwordx4 v3, s[44:47], s10 offen nt lds
    s_waitcnt vmcnt(12)
    s_barrier
    s_add_u32 m0, s15, 81920
    s_mov_b32 s10, 65792
    buffer_load_dwordx4 v3, s[44:47], s10 offen nt lds
    s_add_u32 m0, s15, 86016
    s_mov_b32 s10, 73984
    buffer_load_dwordx4 v3, s[44:47], s10 offen nt lds
    s_add_u32 m0, s15, 90112
    s_mov_b32 s10, 82176
    buffer_load_dwordx4 v3, s[44:47], s10 offen nt lds
    s_add_u32 m0, s15, 94208
    s_mov_b32 s10, 90368
    buffer_load_dwordx4 v3, s[44:47], s10 offen nt lds
    s_waitcnt vmcnt(12)
    s_barrier
    s_add_u32 m0, s15, 98304
    s_mov_b32 s10, 98304
    buffer_load_dwordx4 v3, s[44:47], s10 offen nt lds
    s_add_u32 m0, s15, 102400
    s_mov_b32 s10, 106496
    buffer_load_dwordx4 v3, s[44:47], s10 offen nt lds
    s_add_u32 m0, s15, 106496
    s_mov_b32 s10, 114688
    buffer_load_dwordx4 v3, s[44:47], s10 offen nt lds
    s_add_u32 m0, s15, 110592
    s_mov_b32 s10, 122880
    buffer_load_dwordx4 v3, s[44:47], s10 offen nt lds
    s_waitcnt vmcnt(12)
    s_barrier
    s_add_u32 m0, s15, 114688
    s_mov_b32 s10, 98560
    buffer_load_dwordx4 v3, s[44:47], s10 offen nt lds
    s_add_u32 m0, s15, 118784
    s_mov_b32 s10, 106752
    buffer_load_dwordx4 v3, s[44:47], s10 offen nt lds
    s_add_u32 m0, s15, 122880
    s_mov_b32 s10, 114944
    buffer_load_dwordx4 v3, s[44:47], s10 offen nt lds
    s_add_u32 m0, s15, 126976
    s_mov_b32 s10, 123136
    buffer_load_dwordx4 v3, s[44:47], s10 offen nt lds
    s_waitcnt vmcnt(12)
    s_barrier
    s_add_u32 m0, s15, 131072
    s_mov_b32 s10, 131072
    buffer_load_dwordx4 v3, s[44:47], s10 offen nt lds
    s_add_u32 m0, s15, 135168
    s_mov_b32 s10, 139264
    buffer_load_dwordx4 v3, s[44:47], s10 offen nt lds
    s_add_u32 m0, s15, 139264
    s_mov_b32 s10, 147456
    buffer_load_dwordx4 v3, s[44:47], s10 offen nt lds
    s_add_u32 m0, s15, 143360
    s_mov_b32 s10, 155648
    buffer_load_dwordx4 v3, s[44:47], s10 offen nt lds
    s_waitcnt vmcnt(12)
    s_barrier
    s_add_u32 m0, s15, 16384
    s_mov_b32 s10, 131328
    buffer_load_dwordx4 v3, s[44:47], s10 offen nt lds
    s_add_u32 m0, s15, 20480
    s_mov_b32 s10, 139520
    buffer_load_dwordx4 v3, s[44:47], s10 offen nt lds
    s_add_u32 m0, s15, 24576
    s_mov_b32 s10, 147712
    buffer_load_dwordx4 v3, s[44:47], s10 offen nt lds
    s_add_u32 m0, s15, 28672
    s_mov_b32 s10, 155904
    buffer_load_dwordx4 v3, s[44:47], s10 offen nt lds
    s_waitcnt vmcnt(12)
    s_barrier
    s_add_u32 m0, s15, 32768
    s_mov_b32 s10, 163840
    buffer_load_dwordx4 v3, s[44:47], s10 offen nt lds
    s_add_u32 m0, s15, 36864
    s_mov_b32 s10, 172032
    buffer_load_dwordx4 v3, s[44:47], s10 offen nt lds
    s_add_u32 m0, s15, 40960
    s_mov_b32 s10, 180224
    buffer_load_dwordx4 v3, s[44:47], s10 offen nt lds
    s_add_u32 m0, s15, 45056
    s_mov_b32 s10, 188416
    buffer_load_dwordx4 v3, s[44:47], s10 offen nt lds
    s_waitcnt vmcnt(12)
    s_barrier
    s_add_u32 m0, s15, 147456
    s_mov_b32 s10, 164096
    buffer_load_dwordx4 v3, s[44:47], s10 offen nt lds
    s_add_u32 m0, s15, 151552
    s_mov_b32 s10, 172288
    buffer_load_dwordx4 v3, s[44:47], s10 offen nt lds
    s_add_u32 m0, s15, 155648
    s_mov_b32 s10, 180480
    buffer_load_dwordx4 v3, s[44:47], s10 offen nt lds
    s_add_u32 m0, s15, 159744
    s_mov_b32 s10, 188672
    buffer_load_dwordx4 v3, s[44:47], s10 offen nt lds
    s_waitcnt vmcnt(12)
    s_barrier
    s_add_u32 m0, s15, 0
    s_mov_b32 s10, 196608
    buffer_load_dwordx4 v3, s[44:47], s10 offen nt lds
    s_add_u32 m0, s15, 4096
    s_mov_b32 s10, 204800
    buffer_load_dwordx4 v3, s[44:47], s10 offen nt lds
    s_add_u32 m0, s15, 8192
    s_mov_b32 s10, 212992
    buffer_load_dwordx4 v3, s[44:47], s10 offen nt lds
    s_add_u32 m0, s15, 12288
    s_mov_b32 s10, 221184
    buffer_load_dwordx4 v3, s[44:47], s10 offen nt lds
    s_waitcnt vmcnt(12)
    s_barrier
    s_add_u32 m0, s15, 49152
    s_mov_b32 s10, 196864
    buffer_load_dwordx4 v3, s[44:47], s10 offen nt lds
    s_add_u32 m0, s15, 53248
    s_mov_b32 s10, 205056
    buffer_load_dwordx4 v3, s[44:47], s10 offen nt lds
    s_add_u32 m0, s15, 57344
    s_mov_b32 s10, 213248
    buffer_load_dwordx4 v3, s[44:47], s10 offen nt lds
    s_add_u32 m0, s15, 61440
    s_mov_b32 s10, 221440
    buffer_load_dwordx4 v3, s[44:47], s10 offen nt lds
    s_waitcnt vmcnt(12)
    s_barrier
    s_add_u32 m0, s15, 65536
    s_mov_b32 s10, 229376
    buffer_load_dwordx4 v3, s[44:47], s10 offen nt lds
    s_add_u32 m0, s15, 69632
    s_mov_b32 s10, 237568
    buffer_load_dwordx4 v3, s[44:47], s10 offen nt lds
    s_add_u32 m0, s15, 73728
    s_mov_b32 s10, 245760
    buffer_load_dwordx4 v3, s[44:47], s10 offen nt lds
    s_add_u32 m0, s15, 77824
    s_mov_b32 s10, 253952
    buffer_load_dwordx4 v3, s[44:47], s10 offen nt lds
    s_waitcnt vmcnt(12)
    s_barrier
    s_add_u32 m0, s15, 81920
    s_mov_b32 s10, 229632
    buffer_load_dwordx4 v3, s[44:47], s10 offen nt lds
    s_add_u32 m0, s15, 86016
    s_mov_b32 s10, 237824
    buffer_load_dwordx4 v3, s[44:47], s10 offen nt lds
    s_add_u32 m0, s15, 90112
    s_mov_b32 s10, 246016
    buffer_load_dwordx4 v3, s[44:47], s10 offen nt lds
    s_add_u32 m0, s15, 94208
    s_mov_b32 s10, 254208
    buffer_load_dwordx4 v3, s[44:47], s10 offen nt lds
    s_waitcnt vmcnt(12)
    s_barrier
    s_add_u32 m0, s15, 98304
    s_mov_b32 s10, 0
    buffer_load_dwordx4 v4, s[48:51], s10 offen nt lds
    s_add_u32 m0, s15, 102400
    s_mov_b32 s10, 8192
    buffer_load_dwordx4 v4, s[48:51], s10 offen nt lds
    s_add_u32 m0, s15, 106496
    s_mov_b32 s10, 16384
    buffer_load_dwordx4 v4, s[48:51], s10 offen nt lds
    s_add_u32 m0, s15, 110592
    s_mov_b32 s10, 24576
    buffer_load_dwordx4 v4, s[48:51], s10 offen nt lds
    s_waitcnt vmcnt(12)
    s_barrier
    s_add_u32 m0, s15, 131072
    s_mov_b32 s10, 256
    buffer_load_dwordx4 v4, s[48:51], s10 offen nt lds
    s_add_u32 m0, s15, 135168
    s_mov_b32 s10, 8448
    buffer_load_dwordx4 v4, s[48:51], s10 offen nt lds
    s_add_u32 m0, s15, 139264
    s_mov_b32 s10, 16640
    buffer_load_dwordx4 v4, s[48:51], s10 offen nt lds
    s_add_u32 m0, s15, 143360
    s_mov_b32 s10, 24832
    buffer_load_dwordx4 v4, s[48:51], s10 offen nt lds
    s_waitcnt vmcnt(12)
    s_barrier
    s_add_u32 m0, s15, 32768
    s_mov_b32 s10, 32768
    buffer_load_dwordx4 v4, s[48:51], s10 offen nt lds
    s_add_u32 m0, s15, 36864
    s_mov_b32 s10, 40960
    buffer_load_dwordx4 v4, s[48:51], s10 offen nt lds
    s_add_u32 m0, s15, 40960
    s_mov_b32 s10, 49152
    buffer_load_dwordx4 v4, s[48:51], s10 offen nt lds
    s_add_u32 m0, s15, 45056
    s_mov_b32 s10, 57344
    buffer_load_dwordx4 v4, s[48:51], s10 offen nt lds
    s_waitcnt vmcnt(12)
    s_barrier
    s_add_u32 m0, s15, 147456
    s_mov_b32 s10, 33024
    buffer_load_dwordx4 v4, s[48:51], s10 offen nt lds
    s_add_u32 m0, s15, 151552
    s_mov_b32 s10, 41216
    buffer_load_dwordx4 v4, s[48:51], s10 offen nt lds
    s_add_u32 m0, s15, 155648
    s_mov_b32 s10, 49408
    buffer_load_dwordx4 v4, s[48:51], s10 offen nt lds
    s_add_u32 m0, s15, 159744
    s_mov_b32 s10, 57600
    buffer_load_dwordx4 v4, s[48:51], s10 offen nt lds
    s_waitcnt vmcnt(12)
    s_barrier
    s_add_u32 m0, s15, 0
    s_mov_b32 s10, 65536
    buffer_load_dwordx4 v4, s[48:51], s10 offen nt lds
    s_add_u32 m0, s15, 4096
    s_mov_b32 s10, 73728
    buffer_load_dwordx4 v4, s[48:51], s10 offen nt lds
    s_add_u32 m0, s15, 8192
    s_mov_b32 s10, 81920
    buffer_load_dwordx4 v4, s[48:51], s10 offen nt lds
    s_add_u32 m0, s15, 12288
    s_mov_b32 s10, 90112
    buffer_load_dwordx4 v4, s[48:51], s10 offen nt lds
    s_waitcnt vmcnt(12)
    s_barrier
    s_add_u32 m0, s15, 49152
    s_mov_b32 s10, 65792
    buffer_load_dwordx4 v4, s[48:51], s10 offen nt lds
    s_add_u32 m0, s15, 53248
    s_mov_b32 s10, 73984
    buffer_load_dwordx4 v4, s[48:51], s10 offen nt lds
    s_add_u32 m0, s15, 57344
    s_mov_b32 s10, 82176
    buffer_load_dwordx4 v4, s[48:51], s10 offen nt lds
    s_add_u32 m0, s15, 61440
    s_mov_b32 s10, 90368
    buffer_load_dwordx4 v4, s[48:51], s10 offen nt lds
    s_waitcnt vmcnt(12)
    s_barrier
    s_add_u32 m0, s15, 81920
    s_mov_b32 s10, 98304
    buffer_load_dwordx4 v4, s[48:51], s10 offen nt lds
    s_add_u32 m0, s15, 86016
    s_mov_b32 s10, 106496
    buffer_load_dwordx4 v4, s[48:51], s10 offen nt lds
    s_add_u32 m0, s15, 90112
    s_mov_b32 s10, 114688
    buffer_load_dwordx4 v4, s[48:51], s10 offen nt lds
    s_add_u32 m0, s15, 94208
    s_mov_b32 s10, 122880
    buffer_load_dwordx4 v4, s[48:51], s10 offen nt lds
    s_waitcnt vmcnt(12)
    s_barrier
    s_add_u32 m0, s15, 98304
    s_mov_b32 s10, 98560
    buffer_load_dwordx4 v4, s[48:51], s10 offen nt lds
    s_add_u32 m0, s15, 102400
    s_mov_b32 s10, 106752
    buffer_load_dwordx4 v4, s[48:51], s10 offen nt lds
    s_add_u32 m0, s15, 106496
    s_mov_b32 s10, 114944
    buffer_load_dwordx4 v4, s[48:51], s10 offen nt lds
    s_add_u32 m0, s15, 110592
    s_mov_b32 s10, 123136
    buffer_load_dwordx4 v4, s[48:51], s10 offen nt lds
    s_waitcnt vmcnt(12)
    s_barrier
    s_add_u32 m0, s15, 131072
    s_mov_b32 s10, 131072
    buffer_load_dwordx4 v4, s[48:51], s10 offen nt lds
    s_add_u32 m0, s15, 135168
    s_mov_b32 s10, 139264
    buffer_load_dwordx4 v4, s[48:51], s10 offen nt lds
    s_add_u32 m0, s15, 139264
    s_mov_b32 s10, 147456
    buffer_load_dwordx4 v4, s[48:51], s10 offen nt lds
    s_add_u32 m0, s15, 143360
    s_mov_b32 s10, 155648
    buffer_load_dwordx4 v4, s[48:51], s10 offen nt lds
    s_waitcnt vmcnt(12)
    s_barrier
    s_add_u32 m0, s15, 32768
    s_mov_b32 s10, 131328
    buffer_load_dwordx4 v4, s[48:51], s10 offen nt lds
    s_add_u32 m0, s15, 36864
    s_mov_b32 s10, 139520
    buffer_load_dwordx4 v4, s[48:51], s10 offen nt lds
    s_add_u32 m0, s15, 40960
    s_mov_b32 s10, 147712
    buffer_load_dwordx4 v4, s[48:51], s10 offen nt lds
    s_add_u32 m0, s15, 45056
    s_mov_b32 s10, 155904
    buffer_load_dwordx4 v4, s[48:51], s10 offen nt lds
    s_waitcnt vmcnt(12)
    s_barrier
    s_add_u32 m0, s15, 147456
    s_mov_b32 s10, 163840
    buffer_load_dwordx4 v4, s[48:51], s10 offen nt lds
    s_add_u32 m0, s15, 151552
    s_mov_b32 s10, 172032
    buffer_load_dwordx4 v4, s[48:51], s10 offen nt lds
    s_add_u32 m0, s15, 155648
    s_mov_b32 s10, 180224
    buffer_load_dwordx4 v4, s[48:51], s10 offen nt lds
    s_add_u32 m0, s15, 159744
    s_mov_b32 s10, 188416
    buffer_load_dwordx4 v4, s[48:51], s10 offen nt lds
    s_waitcnt vmcnt(12)
    s_barrier
    s_add_u32 m0, s15, 0
    s_mov_b32 s10, 164096
    buffer_load_dwordx4 v4, s[48:51], s10 offen nt lds
    s_add_u32 m0, s15, 4096
    s_mov_b32 s10, 172288
    buffer_load_dwordx4 v4, s[48:51], s10 offen nt lds
    s_add_u32 m0, s15, 8192
    s_mov_b32 s10, 180480
    buffer_load_dwordx4 v4, s[48:51], s10 offen nt lds
    s_add_u32 m0, s15, 12288
    s_mov_b32 s10, 188672
    buffer_load_dwordx4 v4, s[48:51], s10 offen nt lds
    s_waitcnt vmcnt(12)
    s_barrier
    s_add_u32 m0, s15, 49152
    s_mov_b32 s10, 196608
    buffer_load_dwordx4 v4, s[48:51], s10 offen nt lds
    s_add_u32 m0, s15, 53248
    s_mov_b32 s10, 204800
    buffer_load_dwordx4 v4, s[48:51], s10 offen nt lds
    s_add_u32 m0, s15, 57344
    s_mov_b32 s10, 212992
    buffer_load_dwordx4 v4, s[48:51], s10 offen nt lds
    s_add_u32 m0, s15, 61440
    s_mov_b32 s10, 221184
    buffer_load_dwordx4 v4, s[48:51], s10 offen nt lds
    s_waitcnt vmcnt(12)
    s_barrier
    s_add_u32 m0, s15, 81920
    s_mov_b32 s10, 196864
    buffer_load_dwordx4 v4, s[48:51], s10 offen nt lds
    s_add_u32 m0, s15, 86016
    s_mov_b32 s10, 205056
    buffer_load_dwordx4 v4, s[48:51], s10 offen nt lds
    s_add_u32 m0, s15, 90112
    s_mov_b32 s10, 213248
    buffer_load_dwordx4 v4, s[48:51], s10 offen nt lds
    s_add_u32 m0, s15, 94208
    s_mov_b32 s10, 221440
    buffer_load_dwordx4 v4, s[48:51], s10 offen nt lds
    s_waitcnt vmcnt(12)
    s_barrier
    s_add_u32 m0, s15, 98304
    s_mov_b32 s10, 229376
    buffer_load_dwordx4 v4, s[48:51], s10 offen nt lds
    s_add_u32 m0, s15, 102400
    s_mov_b32 s10, 237568
    buffer_load_dwordx4 v4, s[48:51], s10 offen nt lds
    s_add_u32 m0, s15, 106496
    s_mov_b32 s10, 245760
    buffer_load_dwordx4 v4, s[48:51], s10 offen nt lds
    s_add_u32 m0, s15, 110592
    s_mov_b32 s10, 253952
    buffer_load_dwordx4 v4, s[48:51], s10 offen nt lds
    s_waitcnt vmcnt(12)
    s_barrier
    s_add_u32 m0, s15, 131072
    s_mov_b32 s10, 229632
    buffer_load_dwordx4 v4, s[48:51], s10 offen nt lds
    s_add_u32 m0, s15, 135168
    s_mov_b32 s10, 237824
    buffer_load_dwordx4 v4, s[48:51], s10 offen nt lds
    s_add_u32 m0, s15, 139264
    s_mov_b32 s10, 246016
    buffer_load_dwordx4 v4, s[48:51], s10 offen nt lds
    s_add_u32 m0, s15, 143360
    s_mov_b32 s10, 254208
    buffer_load_dwordx4 v4, s[48:51], s10 offen nt lds
    s_waitcnt vmcnt(12)
    s_barrier
    s_add_u32 m0, s15, 114688
    s_mov_b32 s10, 0
    buffer_load_dwordx4 v5, s[40:43], s10 offen lds
    s_add_u32 m0, s15, 118784
    s_mov_b32 s10, 28672
    buffer_load_dwordx4 v5, s[40:43], s10 offen lds
    s_add_u32 m0, s15, 122880
    s_mov_b32 s10, 57344
    buffer_load_dwordx4 v5, s[40:43], s10 offen lds
    s_add_u32 m0, s15, 126976
    s_mov_b32 s10, 86016
    buffer_load_dwordx4 v5, s[40:43], s10 offen lds
    s_waitcnt vmcnt(12)
    s_barrier
    s_add_u32 m0, s15, 32768
    s_mov_b32 s10, 128
    buffer_load_dwordx4 v5, s[40:43], s10 offen lds
    s_add_u32 m0, s15, 36864
    s_mov_b32 s10, 28800
    buffer_load_dwordx4 v5, s[40:43], s10 offen lds
    s_add_u32 m0, s15, 40960
    s_mov_b32 s10, 57472
    buffer_load_dwordx4 v5, s[40:43], s10 offen lds
    s_add_u32 m0, s15, 45056
    s_mov_b32 s10, 86144
    buffer_load_dwordx4 v5, s[40:43], s10 offen lds
    s_waitcnt vmcnt(12)
    s_barrier
    s_add_u32 m0, s15, 147456
    s_mov_b32 s10, 256
    buffer_load_dwordx4 v5, s[40:43], s10 offen lds
    s_add_u32 m0, s15, 151552
    s_mov_b32 s10, 28928
    buffer_load_dwordx4 v5, s[40:43], s10 offen lds
    s_add_u32 m0, s15, 155648
    s_mov_b32 s10, 57600
    buffer_load_dwordx4 v5, s[40:43], s10 offen lds
    s_add_u32 m0, s15, 159744
    s_mov_b32 s10, 86272
    buffer_load_dwordx4 v5, s[40:43], s10 offen lds
    s_waitcnt vmcnt(12)
    s_barrier
    s_add_u32 m0, s15, 16384
    s_mov_b32 s10, 114688
    buffer_load_dwordx4 v5, s[40:43], s10 offen lds
    s_add_u32 m0, s15, 20480
    s_mov_b32 s10, 143360
    buffer_load_dwordx4 v5, s[40:43], s10 offen lds
    s_add_u32 m0, s15, 24576
    s_mov_b32 s10, 172032
    buffer_load_dwordx4 v5, s[40:43], s10 offen lds
    s_add_u32 m0, s15, 28672
    s_mov_b32 s10, 200704
    buffer_load_dwordx4 v5, s[40:43], s10 offen lds
    s_waitcnt vmcnt(12)
    s_barrier
    s_add_u32 m0, s15, 49152
    s_mov_b32 s10, 384
    buffer_load_dwordx4 v5, s[40:43], s10 offen lds
    s_add_u32 m0, s15, 53248
    s_mov_b32 s10, 29056
    buffer_load_dwordx4 v5, s[40:43], s10 offen lds
    s_add_u32 m0, s15, 57344
    s_mov_b32 s10, 57728
    buffer_load_dwordx4 v5, s[40:43], s10 offen lds
    s_add_u32 m0, s15, 61440
    s_mov_b32 s10, 86400
    buffer_load_dwordx4 v5, s[40:43], s10 offen lds
    s_waitcnt vmcnt(12)
    s_barrier
    s_add_u32 m0, s15, 98304
    s_mov_b32 s10, 114816
    buffer_load_dwordx4 v5, s[40:43], s10 offen lds
    s_add_u32 m0, s15, 102400
    s_mov_b32 s10, 143488
    buffer_load_dwordx4 v5, s[40:43], s10 offen lds
    s_add_u32 m0, s15, 106496
    s_mov_b32 s10, 172160
    buffer_load_dwordx4 v5, s[40:43], s10 offen lds
    s_add_u32 m0, s15, 110592
    s_mov_b32 s10, 200832
    buffer_load_dwordx4 v5, s[40:43], s10 offen lds
    s_waitcnt vmcnt(12)
    s_barrier
    s_add_u32 m0, s15, 65536
    s_mov_b32 s10, 512
    buffer_load_dwordx4 v5, s[40:43], s10 offen lds
    s_add_u32 m0, s15, 69632
    s_mov_b32 s10, 29184
    buffer_load_dwordx4 v5, s[40:43], s10 offen lds
    s_add_u32 m0, s15, 73728
    s_mov_b32 s10, 57856
    buffer_load_dwordx4 v5, s[40:43], s10 offen lds
    s_add_u32 m0, s15, 77824
    s_mov_b32 s10, 86528
    buffer_load_dwordx4 v5, s[40:43], s10 offen lds
    s_waitcnt vmcnt(12)
    s_barrier
    s_add_u32 m0, s15, 131072
    s_mov_b32 s10, 114944
    buffer_load_dwordx4 v5, s[40:43], s10 offen lds
    s_add_u32 m0, s15, 135168
    s_mov_b32 s10, 143616
    buffer_load_dwordx4 v5, s[40:43], s10 offen lds
    s_add_u32 m0, s15, 139264
    s_mov_b32 s10, 172288
    buffer_load_dwordx4 v5, s[40:43], s10 offen lds
    s_add_u32 m0, s15, 143360
    s_mov_b32 s10, 200960
    buffer_load_dwordx4 v5, s[40:43], s10 offen lds
    s_waitcnt vmcnt(12)
    s_barrier
    s_add_u32 m0, s15, 114688
    s_mov_b32 s10, 640
    buffer_load_dwordx4 v5, s[40:43], s10 offen lds
    s_add_u32 m0, s15, 118784
    s_mov_b32 s10, 29312
    buffer_load_dwordx4 v5, s[40:43], s10 offen lds
    s_add_u32 m0, s15, 122880
    s_mov_b32 s10, 57984
    buffer_load_dwordx4 v5, s[40:43], s10 offen lds
    s_add_u32 m0, s15, 126976
    s_mov_b32 s10, 86656
    buffer_load_dwordx4 v5, s[40:43], s10 offen lds
    s_waitcnt vmcnt(12)
    s_barrier
    s_add_u32 m0, s15, 0
    s_mov_b32 s10, 115072
    buffer_load_dwordx4 v5, s[40:43], s10 offen lds
    s_add_u32 m0, s15, 4096
    s_mov_b32 s10, 143744
    buffer_load_dwordx4 v5, s[40:43], s10 offen lds
    s_add_u32 m0, s15, 8192
    s_mov_b32 s10, 172416
    buffer_load_dwordx4 v5, s[40:43], s10 offen lds
    s_add_u32 m0, s15, 12288
    s_mov_b32 s10, 201088
    buffer_load_dwordx4 v5, s[40:43], s10 offen lds
    s_waitcnt vmcnt(12)
    s_barrier
    s_add_u32 m0, s15, 32768
    s_mov_b32 s10, 768
    buffer_load_dwordx4 v5, s[40:43], s10 offen lds
    s_add_u32 m0, s15, 36864
    s_mov_b32 s10, 29440
    buffer_load_dwordx4 v5, s[40:43], s10 offen lds
    s_add_u32 m0, s15, 40960
    s_mov_b32 s10, 58112
    buffer_load_dwordx4 v5, s[40:43], s10 offen lds
    s_add_u32 m0, s15, 45056
    s_mov_b32 s10, 86784
    buffer_load_dwordx4 v5, s[40:43], s10 offen lds
    s_waitcnt vmcnt(12)
    s_barrier
    s_add_u32 m0, s15, 147456
    s_mov_b32 s10, 115200
    buffer_load_dwordx4 v5, s[40:43], s10 offen lds
    s_add_u32 m0, s15, 151552
    s_mov_b32 s10, 143872
    buffer_load_dwordx4 v5, s[40:43], s10 offen lds
    s_add_u32 m0, s15, 155648
    s_mov_b32 s10, 172544
    buffer_load_dwordx4 v5, s[40:43], s10 offen lds
    s_add_u32 m0, s15, 159744
    s_mov_b32 s10, 201216
    buffer_load_dwordx4 v5, s[40:43], s10 offen lds
    s_waitcnt vmcnt(12)
    s_barrier
    s_add_u32 m0, s15, 81920
    s_mov_b32 s10, 115328
    buffer_load_dwordx4 v5, s[40:43], s10 offen lds
    s_add_u32 m0, s15, 86016
    s_mov_b32 s10, 144000
    buffer_load_dwordx4 v5, s[40:43], s10 offen lds
    s_add_u32 m0, s15, 90112
    s_mov_b32 s10, 172672
    buffer_load_dwordx4 v5, s[40:43], s10 offen lds
    s_add_u32 m0, s15, 94208
    s_mov_b32 s10, 201344
    buffer_load_dwordx4 v5, s[40:43], s10 offen lds
    s_waitcnt vmcnt(12)
    s_barrier
    s_add_u32 m0, s15, 16384
    s_mov_b32 s10, 115456
    buffer_load_dwordx4 v5, s[40:43], s10 offen lds
    s_add_u32 m0, s15, 20480
    s_mov_b32 s10, 144128
    buffer_load_dwordx4 v5, s[40:43], s10 offen lds
    s_add_u32 m0, s15, 24576
    s_mov_b32 s10, 172800
    buffer_load_dwordx4 v5, s[40:43], s10 offen lds
    s_add_u32 m0, s15, 28672
    s_mov_b32 s10, 201472
    buffer_load_dwordx4 v5, s[40:43], s10 offen lds
    s_waitcnt vmcnt(12)
    s_barrier
    s_waitcnt vmcnt(8)
    s_barrier
    s_waitcnt vmcnt(4)
    s_barrier
    s_waitcnt vmcnt(0)
    s_barrier
    s_endpgm
L1_end:
    s_endpgm
.section .rodata,"a"
.p2align 6
.amdhsa_kernel gqa_main_kernel
  .amdhsa_next_free_vgpr 256
  .amdhsa_next_free_sgpr 100
  .amdhsa_accum_offset 256
  .amdhsa_group_segment_fixed_size 0
  .amdhsa_kernarg_size 64
  .amdhsa_user_sgpr_count 2
  .amdhsa_user_sgpr_kernarg_segment_ptr 1
  .amdhsa_system_sgpr_workgroup_id_x 1
.end_amdhsa_kernel
.text
.globl gqa_reduce_kernel
.p2align 8
.type gqa_reduce_kernel,@function
gqa_reduce_kernel:
    s_cmp_ge_u32 s2, 224
    s_cbranch_scc1 L2_end
    s_load_dwordx2 s[16:17], s[0:1], 40
    s_load_dwordx2 s[18:19], s[0:1], 56
    v_lshrrev_b32 v1, 6, v0
    v_and_b32 v0, 63, v0
    v_readfirstlane_b32 s3, v1
    s_mul_i32 s4, s2, 4
    s_add_u32 s4, s4, s3
    s_and_b32 s5, s4, 3
    s_bfe_u32 s6, s4, 0x10002
    s_lshr_b32 s7, s4, 3
    s_mul_i32 s8, s7, 9363
    s_lshr_b32 s8, s8, 16
    s_mul_i32 s9, s8, 7
    s_sub_u32 s9, s7, s9
    v_lshrrev_b32 v2, 5, v0
    v_lshlrev_b32 v2, 12, v2
    v_bfe_u32 v3, v0, 3, 2
    v_lshl_add_u32 v2, v3, 9, v2
    v_and_b32 v3, 7, v0
    v_lshl_add_u32 v2, v3, 4, v2
    s_lshl_b32 s10, s9, 13
    s_lshl_b32 s11, s6, 11
    s_add_u32 s10, s10, s11
    s_lshl_b32 s11, s5, 7
    s_add_u32 s10, s10, s11
    s_mul_i32 s11, s8, 917504
    s_add_u32 s10, s10, s11
    v_add_u32 v2, s10, v2
    s_lshl_b32 s12, s8, 6
    s_lshl_b32 s13, s6, 5
    s_add_u32 s12, s12, s13
    s_lshl_b32 s13, s5, 3
    s_add_u32 s12, s12, s13
    s_mul_i32 s12, s12, 896
    s_lshl_b32 s13, s9, 7
    s_add_u32 s12, s12, s13
    v_mul_u32_u24 v4, 896, v3
    v_lshrrev_b32 v3, 3, v0
    v_lshl_add_u32 v4, v3, 4, v4
    v_add_u32 v4, s12, v4
    s_waitcnt lgkmcnt(0)
    s_mov_b32 s20, s18
    s_and_b32 s21, s19, 0xffff
    s_mov_b32 s22, 14680064
    s_mov_b32 s23, 0x20000
    s_mov_b32 s24, s16
    s_and_b32 s25, s17, 0xffff
    s_mov_b32 s26, 917504
    s_mov_b32 s27, 0x20000
    s_mov_b32 s10, 0
    buffer_load_dwordx4 v[16:19], v2, s[20:23], s10 offen
    s_mov_b32 s10, 57344
    buffer_load_dwordx4 v[20:23], v2, s[20:23], s10 offen
    s_mov_b32 s10, 114688
    buffer_load_dwordx4 v[24:27], v2, s[20:23], s10 offen
    s_mov_b32 s10, 172032
    buffer_load_dwordx4 v[28:31], v2, s[20:23], s10 offen
    s_mov_b32 s10, 229376
    buffer_load_dwordx4 v[32:35], v2, s[20:23], s10 offen
    s_mov_b32 s10, 286720
    buffer_load_dwordx4 v[36:39], v2, s[20:23], s10 offen
    s_mov_b32 s10, 344064
    buffer_load_dwordx4 v[40:43], v2, s[20:23], s10 offen
    s_mov_b32 s10, 401408
    buffer_load_dwordx4 v[44:47], v2, s[20:23], s10 offen
    s_mov_b32 s10, 458752
    buffer_load_dwordx4 v[48:51], v2, s[20:23], s10 offen
    s_mov_b32 s10, 516096
    buffer_load_dwordx4 v[52:55], v2, s[20:23], s10 offen
    s_mov_b32 s10, 573440
    buffer_load_dwordx4 v[56:59], v2, s[20:23], s10 offen
    s_mov_b32 s10, 630784
    buffer_load_dwordx4 v[60:63], v2, s[20:23], s10 offen
    s_mov_b32 s10, 688128
    buffer_load_dwordx4 v[64:67], v2, s[20:23], s10 offen
    s_mov_b32 s10, 745472
    buffer_load_dwordx4 v[68:71], v2, s[20:23], s10 offen
    s_mov_b32 s10, 802816
    buffer_load_dwordx4 v[72:75], v2, s[20:23], s10 offen
    s_mov_b32 s10, 860160
    buffer_load_dwordx4 v[76:79], v2, s[20:23], s10 offen
    s_waitcnt vmcnt(15)
    v_lshlrev_b32 v8, 16, v16
    v_and_b32 v9, 0xffff0000, v16
    v_lshlrev_b32 v10, 16, v17
    v_and_b32 v11, 0xffff0000, v17
    v_lshlrev_b32 v12, 16, v18
    v_and_b32 v13, 0xffff0000, v18
    v_lshlrev_b32 v14, 16, v19
    v_and_b32 v15, 0xffff0000, v19
    s_waitcnt vmcnt(14)
    v_lshlrev_b32 v5, 16, v20
    v_and_b32 v6, 0xffff0000, v20
    v_add_f32 v8, v8, v5
    v_add_f32 v9, v9, v6
    v_lshlrev_b32 v5, 16, v21
    v_and_b32 v6, 0xffff0000, v21
    v_add_f32 v10, v10, v5
    v_add_f32 v11, v11, v6
    v_lshlrev_b32 v5, 16, v22
    v_and_b32 v6, 0xffff0000, v22
    v_add_f32 v12, v12, v5
    v_add_f32 v13, v13, v6
    v_lshlrev_b32 v5, 16, v23
    v_and_b32 v6, 0xffff0000, v23
    v_add_f32 v14, v14, v5
    v_add_f32 v15, v15, v6
    s_waitcnt vmcnt(13)
    v_lshlrev_b32 v5, 16, v24
    v_and_b32 v6, 0xffff0000, v24
    v_add_f32 v8, v8, v5
    v_add_f32 v9, v9, v6
    v_lshlrev_b32 v5, 16, v25
    v_and_b32 v6, 0xffff0000, v25
    v_add_f32 v10, v10, v5
    v_add_f32 v11, v11, v6
    v_lshlrev_b32 v5, 16, v26
    v_and_b32 v6, 0xffff0000, v26
    v_add_f32 v12, v12, v5
    v_add_f32 v13, v13, v6
    v_lshlrev_b32 v5, 16, v27
    v_and_b32 v6, 0xffff0000, v27
    v_add_f32 v14, v14, v5
    v_add_f32 v15, v15, v6
    s_waitcnt vmcnt(12)
    v_lshlrev_b32 v5, 16, v28
    v_and_b32 v6, 0xffff0000, v28
    v_add_f32 v8, v8, v5
    v_add_f32 v9, v9, v6
    v_lshlrev_b32 v5, 16, v29
    v_and_b32 v6, 0xffff0000, v29
    v_add_f32 v10, v10, v5
    v_add_f32 v11, v11, v6
    v_lshlrev_b32 v5, 16, v30
    v_and_b32 v6, 0xffff0000, v30
    v_add_f32 v12, v12, v5
    v_add_f32 v13, v13, v6
    v_lshlrev_b32 v5, 16, v31
    v_and_b32 v6, 0xffff0000, v31
    v_add_f32 v14, v14, v5
    v_add_f32 v15, v15, v6
    s_waitcnt vmcnt(11)
    v_lshlrev_b32 v5, 16, v32
    v_and_b32 v6, 0xffff0000, v32
    v_add_f32 v8, v8, v5
    v_add_f32 v9, v9, v6
    v_lshlrev_b32 v5, 16, v33
    v_and_b32 v6, 0xffff0000, v33
    v_add_f32 v10, v10, v5
    v_add_f32 v11, v11, v6
    v_lshlrev_b32 v5, 16, v34
    v_and_b32 v6, 0xffff0000, v34
    v_add_f32 v12, v12, v5
    v_add_f32 v13, v13, v6
    v_lshlrev_b32 v5, 16, v35
    v_and_b32 v6, 0xffff0000, v35
    v_add_f32 v14, v14, v5
    v_add_f32 v15, v15, v6
    s_waitcnt vmcnt(10)
    v_lshlrev_b32 v5, 16, v36
    v_and_b32 v6, 0xffff0000, v36
    v_add_f32 v8, v8, v5
    v_add_f32 v9, v9, v6
    v_lshlrev_b32 v5, 16, v37
    v_and_b32 v6, 0xffff0000, v37
    v_add_f32 v10, v10, v5
    v_add_f32 v11, v11, v6
    v_lshlrev_b32 v5, 16, v38
    v_and_b32 v6, 0xffff0000, v38
    v_add_f32 v12, v12, v5
    v_add_f32 v13, v13, v6
    v_lshlrev_b32 v5, 16, v39
    v_and_b32 v6, 0xffff0000, v39
    v_add_f32 v14, v14, v5
    v_add_f32 v15, v15, v6
    s_waitcnt vmcnt(9)
    v_lshlrev_b32 v5, 16, v40
    v_and_b32 v6, 0xffff0000, v40
    v_add_f32 v8, v8, v5
    v_add_f32 v9, v9, v6
    v_lshlrev_b32 v5, 16, v41
    v_and_b32 v6, 0xffff0000, v41
    v_add_f32 v10, v10, v5
    v_add_f32 v11, v11, v6
    v_lshlrev_b32 v5, 16, v42
    v_and_b32 v6, 0xffff0000, v42
    v_add_f32 v12, v12, v5
    v_add_f32 v13, v13, v6
    v_lshlrev_b32 v5, 16, v43
    v_and_b32 v6, 0xffff0000, v43
    v_add_f32 v14, v14, v5
    v_add_f32 v15, v15, v6
    s_waitcnt vmcnt(8)
    v_lshlrev_b32 v5, 16, v44
    v_and_b32 v6, 0xffff0000, v44
    v_add_f32 v8, v8, v5
    v_add_f32 v9, v9, v6
    v_lshlrev_b32 v5, 16, v45
    v_and_b32 v6, 0xffff0000, v45
    v_add_f32 v10, v10, v5
    v_add_f32 v11, v11, v6
    v_lshlrev_b32 v5, 16, v46
    v_and_b32 v6, 0xffff0000, v46
    v_add_f32 v12, v12, v5
    v_add_f32 v13, v13, v6
    v_lshlrev_b32 v5, 16, v47
    v_and_b32 v6, 0xffff0000, v47
    v_add_f32 v14, v14, v5
    v_add_f32 v15, v15, v6
    s_waitcnt vmcnt(7)
    v_lshlrev_b32 v5, 16, v48
    v_and_b32 v6, 0xffff0000, v48
    v_add_f32 v8, v8, v5
    v_add_f32 v9, v9, v6
    v_lshlrev_b32 v5, 16, v49
    v_and_b32 v6, 0xffff0000, v49
    v_add_f32 v10, v10, v5
    v_add_f32 v11, v11, v6
    v_lshlrev_b32 v5, 16, v50
    v_and_b32 v6, 0xffff0000, v50
    v_add_f32 v12, v12, v5
    v_add_f32 v13, v13, v6
    v_lshlrev_b32 v5, 16, v51
    v_and_b32 v6, 0xffff0000, v51
    v_add_f32 v14, v14, v5
    v_add_f32 v15, v15, v6
    s_waitcnt vmcnt(6)
    v_lshlrev_b32 v5, 16, v52
    v_and_b32 v6, 0xffff0000, v52
    v_add_f32 v8, v8, v5
    v_add_f32 v9, v9, v6
    v_lshlrev_b32 v5, 16, v53
    v_and_b32 v6, 0xffff0000, v53
    v_add_f32 v10, v10, v5
    v_add_f32 v11, v11, v6
    v_lshlrev_b32 v5, 16, v54
    v_and_b32 v6, 0xffff0000, v54
    v_add_f32 v12, v12, v5
    v_add_f32 v13, v13, v6
    v_lshlrev_b32 v5, 16, v55
    v_and_b32 v6, 0xffff0000, v55
    v_add_f32 v14, v14, v5
    v_add_f32 v15, v15, v6
    s_waitcnt vmcnt(5)
    v_lshlrev_b32 v5, 16, v56
    v_and_b32 v6, 0xffff0000, v56
    v_add_f32 v8, v8, v5
    v_add_f32 v9, v9, v6
    v_lshlrev_b32 v5, 16, v57
    v_and_b32 v6, 0xffff0000, v57
    v_add_f32 v10, v10, v5
    v_add_f32 v11, v11, v6
    v_lshlrev_b32 v5, 16, v58
    v_and_b32 v6, 0xffff0000, v58
    v_add_f32 v12, v12, v5
    v_add_f32 v13, v13, v6
    v_lshlrev_b32 v5, 16, v59
    v_and_b32 v6, 0xffff0000, v59
    v_add_f32 v14, v14, v5
    v_add_f32 v15, v15, v6
    s_waitcnt vmcnt(4)
    v_lshlrev_b32 v5, 16, v60
    v_and_b32 v6, 0xffff0000, v60
    v_add_f32 v8, v8, v5
    v_add_f32 v9, v9, v6
    v_lshlrev_b32 v5, 16, v61
    v_and_b32 v6, 0xffff0000, v61
    v_add_f32 v10, v10, v5
    v_add_f32 v11, v11, v6
    v_lshlrev_b32 v5, 16, v62
    v_and_b32 v6, 0xffff0000, v62
    v_add_f32 v12, v12, v5
    v_add_f32 v13, v13, v6
    v_lshlrev_b32 v5, 16, v63
    v_and_b32 v6, 0xffff0000, v63
    v_add_f32 v14, v14, v5
    v_add_f32 v15, v15, v6
    s_waitcnt vmcnt(3)
    v_lshlrev_b32 v5, 16, v64
    v_and_b32 v6, 0xffff0000, v64
    v_add_f32 v8, v8, v5
    v_add_f32 v9, v9, v6
    v_lshlrev_b32 v5, 16, v65
    v_and_b32 v6, 0xffff0000, v65
    v_add_f32 v10, v10, v5
    v_add_f32 v11, v11, v6
    v_lshlrev_b32 v5, 16, v66
    v_and_b32 v6, 0xffff0000, v66
    v_add_f32 v12, v12, v5
    v_add_f32 v13, v13, v6
    v_lshlrev_b32 v5, 16, v67
    v_and_b32 v6, 0xffff0000, v67
    v_add_f32 v14, v14, v5
    v_add_f32 v15, v15, v6
    s_waitcnt vmcnt(2)
    v_lshlrev_b32 v5, 16, v68
    v_and_b32 v6, 0xffff0000, v68
    v_add_f32 v8, v8, v5
    v_add_f32 v9, v9, v6
    v_lshlrev_b32 v5, 16, v69
    v_and_b32 v6, 0xffff0000, v69
    v_add_f32 v10, v10, v5
    v_add_f32 v11, v11, v6
    v_lshlrev_b32 v5, 16, v70
    v_and_b32 v6, 0xffff0000, v70
    v_add_f32 v12, v12, v5
    v_add_f32 v13, v13, v6
    v_lshlrev_b32 v5, 16, v71
    v_and_b32 v6, 0xffff0000, v71
    v_add_f32 v14, v14, v5
    v_add_f32 v15, v15, v6
    s_waitcnt vmcnt(1)
    v_lshlrev_b32 v5, 16, v72
    v_and_b32 v6, 0xffff0000, v72
    v_add_f32 v8, v8, v5
    v_add_f32 v9, v9, v6
    v_lshlrev_b32 v5, 16, v73
    v_and_b32 v6, 0xffff0000, v73
    v_add_f32 v10, v10, v5
    v_add_f32 v11, v11, v6
    v_lshlrev_b32 v5, 16, v74
    v_and_b32 v6, 0xffff0000, v74
    v_add_f32 v12, v12, v5
    v_add_f32 v13, v13, v6
    v_lshlrev_b32 v5, 16, v75
    v_and_b32 v6, 0xffff0000, v75
    v_add_f32 v14, v14, v5
    v_add_f32 v15, v15, v6
    s_waitcnt vmcnt(0)
    v_lshlrev_b32 v5, 16, v76
    v_and_b32 v6, 0xffff0000, v76
    v_add_f32 v8, v8, v5
    v_add_f32 v9, v9, v6
    v_lshlrev_b32 v5, 16, v77
    v_and_b32 v6, 0xffff0000, v77
    v_add_f32 v10, v10, v5
    v_add_f32 v11, v11, v6
    v_lshlrev_b32 v5, 16, v78
    v_and_b32 v6, 0xffff0000, v78
    v_add_f32 v12, v12, v5
    v_add_f32 v13, v13, v6
    v_lshlrev_b32 v5, 16, v79
    v_and_b32 v6, 0xffff0000, v79
    v_add_f32 v14, v14, v5
    v_add_f32 v15, v15, v6
    v_cvt_pk_bf16_f32 v16, v8, v9
    v_cvt_pk_bf16_f32 v17, v10, v11
    v_cvt_pk_bf16_f32 v18, v12, v13
    v_cvt_pk_bf16_f32 v19, v14, v15
    buffer_store_dwordx4 v[16:19], v4, s[24:27], 0 offen
L2_end:
    s_endpgm
.section .rodata,"a"
.p2align 6
.amdhsa_kernel gqa_reduce_kernel
  .amdhsa_next_free_vgpr 80
  .amdhsa_next_free_sgpr 32
  .amdhsa_accum_offset 80
  .amdhsa_group_segment_fixed_size 0
  .amdhsa_kernarg_size 64
  .amdhsa_user_sgpr_count 2
  .amdhsa_user_sgpr_kernarg_segment_ptr 1
  .amdhsa_system_sgpr_workgroup_id_x 1
.end_amdhsa_kernel
.text
```
